```python
import torch

def _softmax(x, axis=-1):
    return torch.softmax(x, dim=axis)
def _gelu(x):
    return torch.nn.functional.gelu(x, approximate="tanh")
def _silu(x):
    return torch.nn.functional.silu(x)
def _sigmoid(x):
    return torch.sigmoid(x)
def _layernorm(x, axis=-1, eps=1e-5):
    m = x.mean(dim=axis, keepdim=True)
    v = x.var(dim=axis, keepdim=True, unbiased=False)
    return (x - m) / torch.sqrt(v + eps)
def _scatter_add(tgt, idx, src, axis=0):
    return tgt.clone().index_add_(axis, idx, src)
def _segment_sum(src, seg, n):
    out = torch.zeros((n,) + src.shape[1:], dtype=src.dtype)
    return out.index_add_(0, seg, src)
def _pad(x, pw):
    flat = tuple(v for pair in reversed(pw) for v in pair)
    return torch.nn.functional.pad(x, flat)

kernel_name = 'recurrent_scan__gqa_block_cached__mixer_channel_mlp__decode'

def setup_inputs():

    _w = (lambda a: (lambda t: t.to(torch.bfloat16) if t.is_floating_point() else t)(torch.as_tensor(a)))
    def _A_setup():
        B, Sq, D = 2, 1, 512
        Hq, Hkv, Sk, Dh = 32, 8, 32768, 128
        assert Hq % Hkv == 0, (Hq, Hkv)
        return {
            "x": _w((lambda *s: torch.randn(*s, dtype=torch.bfloat16) * 0.1)(B, Sq, D)),
            "k_cache": _w((lambda *s: torch.randn(*s, dtype=torch.bfloat16) * 0.8)(B, Hkv, Sk, Dh)),
            "v_cache": _w((lambda *s: torch.randn(*s, dtype=torch.bfloat16) * 3.2)(B, Hkv, Sk, Dh)),
            "wq": _w((lambda *s: torch.randn(*s, dtype=torch.bfloat16) * 0.8)(D, Hq * Dh) * (D ** -0.5)),
            "wo": _w((lambda *s: torch.randn(*s, dtype=torch.bfloat16) * 3.2)(Hq * Dh, D) * ((Hq * Dh) ** -0.5)),
        }
    _A_in = _A_setup()

    def _B_setup():
        B, S, D, F = 2, 1, 512, 1792
        return {
            "x": _w((lambda *s: torch.randn(*s, dtype=torch.bfloat16) * 0.1)(B, S, D)),
            "w1": _w((lambda *s: torch.randn(*s, dtype=torch.bfloat16) * 3.2)(D, F) * (D ** -0.5)),
            "b1": _w((lambda *s: torch.randn(*s, dtype=torch.bfloat16) * 3.2)(F)),
            "w2": _w((lambda *s: torch.randn(*s, dtype=torch.bfloat16) * 3.2)(F, D) * (F ** -0.5)),
            "b2": _w((lambda *s: torch.randn(*s, dtype=torch.bfloat16) * 3.2)(D)),
        }
    _B_in = _B_setup()

    return {
        "A_x": _A_in["x"],
        "A_k_cache": _A_in["k_cache"],
        "A_v_cache": _A_in["v_cache"],
        "A_wq": _A_in["wq"],
        "A_wo": _A_in["wo"],
        "B_x": _B_in["x"],
        "B_w1": _B_in["w1"],
        "B_b1": _B_in["b1"],
        "B_w2": _B_in["w2"],
        "B_b2": _B_in["b2"],
    }

def reference(A_x, A_k_cache, A_v_cache, A_wq, A_wo, B_x, B_w1, B_b1, B_w2, B_b2):
    def _A_ref(x, k_cache, v_cache, wq, wo):
        B, Sq, D = x.shape
        Hq, Dh = 32, 128
        Hkv = k_cache.shape[1]
        rep = Hq // Hkv
        q = (lambda x, *d: x.permute(*d))((x @ wq).reshape(B, Sq, Hq, Dh), 0, 2, 1, 3)
        k = (lambda x, n, axis: torch.repeat_interleave(x, n, dim=axis))(k_cache, rep, axis=1)
        v = (lambda x, n, axis: torch.repeat_interleave(x, n, dim=axis))(v_cache, rep, axis=1)
        scores = torch.einsum("bhqd,bhkd->bhqk", q, k) * (Dh ** -0.5)
        p = _softmax(scores, axis=-1)
        o = torch.einsum("bhqk,bhkd->bhqd", p, v)
        return (lambda x, *d: x.permute(*d))(o, 0, 2, 1, 3).reshape(B, Sq, Hq * Dh) @ wo

    def _B_ref(x, w1, b1, w2, b2):
        y = _layernorm(x, axis=-1)
        h = _gelu(torch.einsum("bsd,df->bsf", y, w1) + b1)
        return torch.einsum("bsf,fd->bsd", h, w2) + b2

    x = A_x
    xn = _layernorm(x, axis=-1)
    s = _A_ref(xn, A_k_cache, A_v_cache, A_wq, A_wo)
    g = _silu(_B_ref(xn, B_w1, B_b1, B_w2, B_b2))
    return x + s * g
```

```asm
; @launch grid=(256,1,1) block=(512,1,1) lds=16384
.amdgcn_target "amdgcn-amd-amdhsa--gfx950"
.text
.globl recurrent_scan__gqa_block_cached__mixer_channel_mlp__decode_kernel
.p2align 8
.type recurrent_scan__gqa_block_cached__mixer_channel_mlp__decode_kernel,@function
recurrent_scan__gqa_block_cached__mixer_channel_mlp__decode_kernel:
  s_cmp_ge_u32 s2, 0x100
  s_cbranch_scc1 L_exit
  s_load_dwordx16 s[32:47], s[0:1], 0
  s_load_dwordx2 s[12:13], s[0:1], 96
  s_load_dwordx8 s[48:55], s[0:1], 64
  v_lshrrev_b32 v1, 6, v0
  v_and_b32 v0, 63, v0
  v_readfirstlane_b32 s3, v1
  s_and_b32 s20, s2, 7
  s_lshl_b32 s20, s20, 5
  s_lshr_b32 s25, s2, 3
  s_add_u32 s20, s20, s25
  s_mov_b32 s14, 8388608
  s_mov_b32 s15, 0x00020000
  s_mov_b32 s7, 0x00020000
  s_mov_b32 s11, 0x00020000
  s_sub_u32 s24, s3, 4
  s_cmp_ge_u32 s24, 3
  s_cbranch_scc1 L_stream
  s_setprio 3
  s_cmp_eq_u32 s3, 4
  s_cbranch_scc1 L_h0a
  s_cmp_lt_u32 s2, 224
  s_cselect_b32 s24, s24, 0
  s_cmp_eq_u32 s24, 1
  s_cbranch_scc1 L_h1a
  v_mov_b32 v8, 0
  v_mov_b32 v9, 13312
  ds_write_b32 v9, v8
  s_waitcnt lgkmcnt(0)
  s_barrier
  s_branch L_hinit
L_h0a:
  v_bfe_u32 v1, v0, 3, 1
  v_lshrrev_b32 v2, 4, v0
  v_and_b32 v3, 15, v0
  v_and_b32 v12, 7, v0
  v_lshl_or_b32 v12, v2, 3, v12
  v_lshlrev_b32 v12, 5, v12
  v_lshl_or_b32 v12, v1, 10, v12
  v_lshlrev_b32 v13, 5, v2
  v_lshl_or_b32 v13, v1, 10, v13
  v_lshlrev_b32 v14, 4, v3
  v_lshl_or_b32 v14, v2, 17, v14
  v_mov_b32 v15, 0
  s_and_b32 s24, s2, 7
  s_lshl_b32 s26, s24, 19
  s_lshl_b32 s27, s25, 8
  s_add_u32 s26, s26, s27
  s_lshl_b32 s27, s24, 7
  s_mov_b32 s6, 2048
  s_mov_b32 s10, 516352
  s_mov_b32 s28, 0
  s_waitcnt lgkmcnt(0)
  s_mov_b32 s4, s32
  s_mov_b32 s5, s33
  s_add_u32 s8, s38, s26
  s_addc_u32 s9, s39, 0
  buffer_load_dwordx4 v[32:35], v12, s[4:7], 0 offen
  buffer_load_dwordx4 v[36:39], v12, s[4:7], 0 offen offset:16
  buffer_load_dwordx4 v[40:43], v13, s[4:7], s27 offen
  buffer_load_dwordx4 v[44:47], v13, s[4:7], s27 offen offset:16
  buffer_load_dwordx4 v[64:67], v14, s[8:11], s28 offen nt
  s_add_u32 s28, s28, 0x2000
  buffer_load_dwordx4 v[68:71], v14, s[8:11], s28 offen nt
  s_add_u32 s28, s28, 0x2000
  buffer_load_dwordx4 v[72:75], v14, s[8:11], s28 offen nt
  s_add_u32 s28, s28, 0x2000
  buffer_load_dwordx4 v[76:79], v14, s[8:11], s28 offen nt
  s_add_u32 s28, s28, 0x2000
  buffer_load_dwordx4 v[80:83], v14, s[8:11], s28 offen nt
  s_add_u32 s28, s28, 0x2000
  buffer_load_dwordx4 v[84:87], v14, s[8:11], s28 offen nt
  s_add_u32 s28, s28, 0x2000
  buffer_load_dwordx4 v[88:91], v14, s[8:11], s28 offen nt
  s_add_u32 s28, s28, 0x2000
  buffer_load_dwordx4 v[92:95], v14, s[8:11], s28 offen nt
  s_add_u32 s28, s28, 0x2000
  buffer_load_dwordx4 v[96:99], v14, s[8:11], s28 offen nt
  s_add_u32 s28, s28, 0x2000
  buffer_load_dwordx4 v[100:103], v14, s[8:11], s28 offen nt
  s_add_u32 s28, s28, 0x2000
  buffer_load_dwordx4 v[104:107], v14, s[8:11], s28 offen nt
  s_add_u32 s28, s28, 0x2000
  buffer_load_dwordx4 v[108:111], v14, s[8:11], s28 offen nt
  s_add_u32 s28, s28, 0x2000
  buffer_load_dwordx4 v[112:115], v14, s[8:11], s28 offen nt
  s_add_u32 s28, s28, 0x2000
  buffer_load_dwordx4 v[116:119], v14, s[8:11], s28 offen nt
  s_add_u32 s28, s28, 0x2000
  buffer_load_dwordx4 v[120:123], v14, s[8:11], s28 offen nt
  s_add_u32 s28, s28, 0x2000
  buffer_load_dwordx4 v[124:127], v14, s[8:11], s28 offen nt
  s_barrier
  s_load_dword s31, s[12:13], 0
  s_branch L_h0b
L_h1a:
  v_bfe_u32 v1, v0, 3, 1
  v_lshrrev_b32 v2, 4, v0
  v_and_b32 v3, 15, v0
  v_and_b32 v13, 7, v0
  v_lshl_or_b32 v14, v2, 3, v13
  v_lshlrev_b32 v14, 5, v14
  v_lshl_or_b32 v14, v1, 10, v14
  v_bfe_u32 v15, v0, 2, 1
  v_lshl_or_b32 v15, v2, 1, v15
  v_lshlrev_b32 v15, 4, v15
  v_lshl_or_b32 v15, v1, 10, v15
  v_lshl_or_b32 v16, v2, 1, v1
  v_mul_u32_u24 v16, 28672, v16
  v_lshl_add_u32 v16, v13, 4, v16
  s_and_b32 s24, s2, 7
  s_lshl_b32 s26, s24, 7
  s_mul_i32 s27, s24, 229376
  s_lshl_b32 s28, s25, 7
  s_add_u32 s27, s27, s28
  s_mov_b32 s6, 2048
  s_mov_b32 s10, 225920
  s_mov_b32 s28, 0
  s_waitcnt lgkmcnt(0)
  s_mov_b32 s4, s32
  s_mov_b32 s5, s33
  s_add_u32 s8, s44, s27
  s_addc_u32 s9, s45, 0
  buffer_load_dwordx4 v[32:35], v14, s[4:7], 0 offen
  buffer_load_dwordx4 v[36:39], v14, s[4:7], 0 offen offset:16
  buffer_load_dwordx4 v[40:43], v15, s[4:7], s26 offen
  buffer_load_dwordx4 v[64:67], v16, s[8:11], s28 offen offset:0 nt
  buffer_load_dwordx4 v[68:71], v16, s[8:11], s28 offen offset:3584 nt
  s_add_u32 s28, s28, 7168
  buffer_load_dwordx4 v[72:75], v16, s[8:11], s28 offen offset:0 nt
  buffer_load_dwordx4 v[76:79], v16, s[8:11], s28 offen offset:3584 nt
  s_add_u32 s28, s28, 7168
  buffer_load_dwordx4 v[80:83], v16, s[8:11], s28 offen offset:0 nt
  buffer_load_dwordx4 v[84:87], v16, s[8:11], s28 offen offset:3584 nt
  s_add_u32 s28, s28, 7168
  buffer_load_dwordx4 v[88:91], v16, s[8:11], s28 offen offset:0 nt
  buffer_load_dwordx4 v[92:95], v16, s[8:11], s28 offen offset:3584 nt
  s_barrier
  s_branch L_h1b
L_stream:
  s_lshl_b32 s24, s3, 12
  v_and_b32 v2, 3, v0
  v_lshlrev_b32 v2, 10, v2
  v_bfe_u32 v1, v0, 2, 2
  v_lshl_or_b32 v2, v1, 8, v2
  v_lshrrev_b32 v1, 4, v0
  v_lshl_or_b32 v2, v1, 4, v2
  v_add_u32 v2, s24, v2
  v_lshl_add_u32 v3, v0, 4, s24
  s_lshl_b32 s29, s20, 19
  s_mov_b32 s6, 0x80000
  s_mov_b32 s10, 0x80000
  s_mov_b32 s23, 0
  s_cmp_eq_u32 s3, 7
  s_cselect_b64 exec, 0, -1
  v_mov_b32 v36, 0
  v_mov_b32 v37, 0
  v_mov_b32 v40, 0
  v_mov_b32 v41, 0
  v_mov_b32 v44, 0
  v_mov_b32 v45, 0
  v_mov_b32 v48, 0
  v_mov_b32 v49, 0
  v_mov_b32 v52, 0
  v_mov_b32 v53, 0
  v_mov_b32 v25, 0
  v_mov_b32 v28, 0
  v_mov_b32 v29, 0
  v_mov_b32 v30, 0
  v_mov_b32 v31, 0
  v_mov_b32 v32, 0
  v_mov_b32 v33, 0
  v_mov_b32 v34, 0
  v_mov_b32 v35, 0
  v_mov_b32 v24, 0xff7fffff
  s_mov_b32 s25, 0x3e0293ee
  v_and_b32 v26, 1, v0
  v_cmp_eq_u32 vcc, 1, v26
  v_mov_b32 v54, 0x0c0c0100
  v_mov_b32 v27, 0x01000c0c
  v_cndmask_b32 v54, v54, v27, vcc
  v_mov_b32 v55, 0x0c0c0302
  v_mov_b32 v27, 0x03020c0c
  v_cndmask_b32 v55, v55, v27, vcc
  v_and_b32 v26, 2, v0
  v_cmp_eq_u32 vcc, 2, v26
  v_mov_b32 v27, 0x0c0c0c0c
  v_bfe_u32 v26, v0, 2, 2
  v_cndmask_b32 v56, v27, v54, vcc
  v_cndmask_b32 v57, v27, v55, vcc
  v_cndmask_b32 v54, v54, v27, vcc
  v_cndmask_b32 v55, v55, v27, vcc
  v_lshrrev_b32 v27, 4, v0
  v_lshlrev_b32 v62, 8, v26
  v_lshl_or_b32 v62, v27, 4, v62
  v_lshlrev_b32 v63, 4, v0
  s_lshl_b32 s24, s3, 9
  s_add_u32 s24, s24, 1024
  v_lshl_add_u32 v59, v0, 3, s24
  s_lshl_b32 s24, s3, 3
  s_add_u32 s24, s24, 9216
  v_lshl_add_u32 v1, v26, 5, s24
  s_lshl_b32 s24, s3, 11
  s_add_u32 s24, s24, 1024
  v_and_b32 v0, 15, v0
  v_lshlrev_b32 v0, 5, v0
  v_lshl_or_b32 v0, v27, 9, v0
  v_add_u32 v0, s24, v0
  s_lshr_b32 s24, s20, 4
  s_lshl_b32 s24, s24, 2
  s_add_u32 s24, s24, s3
  s_lshl_b32 s24, s24, 4
  s_and_b32 s26, s20, 15
  s_add_u32 s24, s24, s26
  s_mul_i32 s27, s24, 1024
  s_add_u32 s27, s27, 1048576
  s_lshl_b32 s28, s24, 4
  s_add_u32 s28, s28, 2621440
  s_waitcnt lgkmcnt(0)
  s_add_u32 s4, s34, s29
  s_addc_u32 s5, s35, 0
  s_add_u32 s8, s36, s29
  s_addc_u32 s9, s37, 0
  s_load_dword s21, s[12:13], 0
  s_barrier
  s_cbranch_execz L_pro
  buffer_load_dwordx4 v[64:67], v2, s[4:7], s23 offen offset:0 nt
  buffer_load_dwordx4 v[68:71], v2, s[4:7], s23 offen offset:64 nt
  buffer_load_dwordx4 v[72:75], v2, s[4:7], s23 offen offset:128 nt
  buffer_load_dwordx4 v[76:79], v2, s[4:7], s23 offen offset:192 nt
  buffer_load_dwordx4 v[80:83], v3, s[8:11], s23 offen offset:0 nt
  buffer_load_dwordx4 v[84:87], v3, s[8:11], s23 offen offset:1024 nt
  buffer_load_dwordx4 v[88:91], v3, s[8:11], s23 offen offset:2048 nt
  buffer_load_dwordx4 v[92:95], v3, s[8:11], s23 offen offset:3072 nt
  s_add_u32 s23, s23, 16384
  buffer_load_dwordx4 v[96:99], v2, s[4:7], s23 offen offset:0 nt
  buffer_load_dwordx4 v[100:103], v2, s[4:7], s23 offen offset:64 nt
  buffer_load_dwordx4 v[104:107], v2, s[4:7], s23 offen offset:128 nt
  buffer_load_dwordx4 v[108:111], v2, s[4:7], s23 offen offset:192 nt
  buffer_load_dwordx4 v[112:115], v3, s[8:11], s23 offen offset:0 nt
  buffer_load_dwordx4 v[116:119], v3, s[8:11], s23 offen offset:1024 nt
  buffer_load_dwordx4 v[120:123], v3, s[8:11], s23 offen offset:2048 nt
  buffer_load_dwordx4 v[124:127], v3, s[8:11], s23 offen offset:3072 nt
  s_add_u32 s23, s23, 16384
  s_waitcnt vmcnt(12)
  buffer_load_dwordx4 v[128:131], v2, s[4:7], s23 offen offset:0 nt
  buffer_load_dwordx4 v[132:135], v2, s[4:7], s23 offen offset:64 nt
  buffer_load_dwordx4 v[136:139], v2, s[4:7], s23 offen offset:128 nt
  buffer_load_dwordx4 v[140:143], v2, s[4:7], s23 offen offset:192 nt
  s_waitcnt vmcnt(12)
  buffer_load_dwordx4 v[144:147], v3, s[8:11], s23 offen offset:0 nt
  buffer_load_dwordx4 v[148:151], v3, s[8:11], s23 offen offset:1024 nt
  buffer_load_dwordx4 v[152:155], v3, s[8:11], s23 offen offset:2048 nt
  buffer_load_dwordx4 v[156:159], v3, s[8:11], s23 offen offset:3072 nt
  s_add_u32 s23, s23, 16384
  s_waitcnt vmcnt(12)
  buffer_load_dwordx4 v[160:163], v2, s[4:7], s23 offen offset:0 nt
  buffer_load_dwordx4 v[164:167], v2, s[4:7], s23 offen offset:64 nt
  buffer_load_dwordx4 v[168:171], v2, s[4:7], s23 offen offset:128 nt
  buffer_load_dwordx4 v[172:175], v2, s[4:7], s23 offen offset:192 nt
  s_waitcnt vmcnt(12)
  buffer_load_dwordx4 v[176:179], v3, s[8:11], s23 offen offset:0 nt
  buffer_load_dwordx4 v[180:183], v3, s[8:11], s23 offen offset:1024 nt
  buffer_load_dwordx4 v[184:187], v3, s[8:11], s23 offen offset:2048 nt
  buffer_load_dwordx4 v[188:191], v3, s[8:11], s23 offen offset:3072 nt
  s_add_u32 s23, s23, 16384
  s_waitcnt vmcnt(12)
  buffer_load_dwordx4 v[192:195], v2, s[4:7], s23 offen offset:0 nt
  buffer_load_dwordx4 v[196:199], v2, s[4:7], s23 offen offset:64 nt
  buffer_load_dwordx4 v[200:203], v2, s[4:7], s23 offen offset:128 nt
  buffer_load_dwordx4 v[204:207], v2, s[4:7], s23 offen offset:192 nt
  s_waitcnt vmcnt(12)
  buffer_load_dwordx4 v[208:211], v3, s[8:11], s23 offen offset:0 nt
  buffer_load_dwordx4 v[212:215], v3, s[8:11], s23 offen offset:1024 nt
  buffer_load_dwordx4 v[216:219], v3, s[8:11], s23 offen offset:2048 nt
  buffer_load_dwordx4 v[220:223], v3, s[8:11], s23 offen offset:3072 nt
  s_add_u32 s23, s23, 16384
  s_waitcnt vmcnt(12)
  buffer_load_dwordx4 v[224:227], v2, s[4:7], s23 offen offset:0 nt
  buffer_load_dwordx4 v[228:231], v2, s[4:7], s23 offen offset:64 nt
  buffer_load_dwordx4 v[232:235], v2, s[4:7], s23 offen offset:128 nt
  buffer_load_dwordx4 v[236:239], v2, s[4:7], s23 offen offset:192 nt
  s_waitcnt vmcnt(12)
  buffer_load_dwordx4 v[240:243], v3, s[8:11], s23 offen offset:0 nt
  buffer_load_dwordx4 v[244:247], v3, s[8:11], s23 offen offset:1024 nt
  buffer_load_dwordx4 v[248:251], v3, s[8:11], s23 offen offset:2048 nt
  buffer_load_dwordx4 v[252:255], v3, s[8:11], s23 offen offset:3072 nt
  s_add_u32 s23, s23, 16384
  s_waitcnt lgkmcnt(0)
  s_mul_i32 s21, s21, 0x9E3779B1
  s_add_u32 s21, s21, 0x7F4A7C15
  s_barrier
L_pro:
  ds_read_b128 v[4:7], v62 offset:0
  ds_read_b128 v[8:11], v62 offset:64
  ds_read_b128 v[12:15], v62 offset:128
  ds_read_b128 v[16:19], v62 offset:192
  s_cmp_eq_u32 s3, 7
  s_cselect_b32 s26, 1, 8
  s_waitcnt lgkmcnt(0)
  v_mfma_f32_16x16x32_bf16 v[20:23], v[64:67], v[4:7], 0
  v_mfma_f32_16x16x32_bf16 v[20:23], v[68:71], v[8:11], v[20:23]
  v_mfma_f32_16x16x32_bf16 v[20:23], v[72:75], v[12:15], v[20:23]
  v_mfma_f32_16x16x32_bf16 v[20:23], v[76:79], v[16:19], v[20:23]
  s_cbranch_execz L_sk12
  buffer_load_dwordx4 v[64:67], v2, s[4:7], s23 offen offset:0 nt
  buffer_load_dwordx4 v[68:71], v2, s[4:7], s23 offen offset:64 nt
  buffer_load_dwordx4 v[72:75], v2, s[4:7], s23 offen offset:128 nt
  buffer_load_dwordx4 v[76:79], v2, s[4:7], s23 offen offset:192 nt
L_sk12:
  s_nop 2
  v_max3_f32 v26, v20, v21, v22
  v_max_f32 v26, v26, v23
  v_mov_b32 v27, v26
  s_nop 1
  v_permlane32_swap_b32 v26, v27
  v_max_f32 v26, v26, v27
  v_mov_b32 v27, v26
  s_nop 1
  v_permlane16_swap_b32 v26, v27
  v_max_f32 v26, v26, v27
  v_mul_f32 v26, s25, v26
  v_max_f32 v26, v24, v26
  v_sub_f32 v62, v24, v26
  v_fma_f32 v20, v20, s25, -v26
  v_fma_f32 v21, v21, s25, -v26
  v_fma_f32 v22, v22, s25, -v26
  v_fma_f32 v23, v23, s25, -v26
  v_exp_f32 v62, v62
  v_exp_f32 v20, v20
  v_exp_f32 v21, v21
  v_mov_b32_dpp v58, v62 row_newbcast:0 row_mask:0x1 bank_mask:0xf
  v_exp_f32 v22, v22
  v_exp_f32 v23, v23
  v_mov_b32_dpp v58, v62 row_newbcast:4 row_mask:0x2 bank_mask:0xf
  v_mov_b32 v24, v26
  v_cvt_pk_bf16_f32 v60, v20, v21
  v_mov_b32_dpp v58, v62 row_newbcast:8 row_mask:0x4 bank_mask:0xf
  v_cvt_pk_bf16_f32 v61, v22, v23
  v_add_f32 v27, v20, v21
  v_mov_b32_dpp v58, v62 row_newbcast:12 row_mask:0x8 bank_mask:0xf
  v_add_f32 v26, v22, v23
  v_perm_b32 v38, v60, v60, v54
  v_perm_b32 v39, v60, v60, v56
  v_perm_b32 v42, v60, v60, v55
  v_perm_b32 v43, v60, v60, v57
  v_perm_b32 v46, v61, v61, v54
  v_perm_b32 v47, v61, v61, v56
  v_perm_b32 v50, v61, v61, v55
  v_perm_b32 v51, v61, v61, v57
  v_add_f32 v27, v27, v26
  v_pk_mul_f32 v[28:29], v[28:29], v[58:59] op_sel_hi:[1,0]
  v_pk_mul_f32 v[30:31], v[30:31], v[58:59] op_sel_hi:[1,0]
  v_pk_mul_f32 v[32:33], v[32:33], v[58:59] op_sel_hi:[1,0]
  v_pk_mul_f32 v[34:35], v[34:35], v[58:59] op_sel_hi:[1,0]
  v_fma_f32 v25, v25, v62, v27
  v_mfma_f32_16x16x32_bf16 v[28:31], v[38:41], v[80:83], v[28:31]
  v_mfma_f32_16x16x32_bf16 v[32:35], v[36:39], v[80:83], v[32:35]
  v_mfma_f32_16x16x32_bf16 v[28:31], v[42:45], v[84:87], v[28:31]
  v_mfma_f32_16x16x32_bf16 v[32:35], v[40:43], v[84:87], v[32:35]
  v_mfma_f32_16x16x32_bf16 v[28:31], v[46:49], v[88:91], v[28:31]
  v_mfma_f32_16x16x32_bf16 v[32:35], v[44:47], v[88:91], v[32:35]
  v_mfma_f32_16x16x32_bf16 v[28:31], v[50:53], v[92:95], v[28:31]
  v_mfma_f32_16x16x32_bf16 v[32:35], v[48:51], v[92:95], v[32:35]
  s_cbranch_execz L_sk13
  buffer_load_dwordx4 v[80:83], v3, s[8:11], s23 offen offset:0 nt
  buffer_load_dwordx4 v[84:87], v3, s[8:11], s23 offen offset:1024 nt
  buffer_load_dwordx4 v[88:91], v3, s[8:11], s23 offen offset:2048 nt
  buffer_load_dwordx4 v[92:95], v3, s[8:11], s23 offen offset:3072 nt
L_sk13:
  s_add_u32 s23, s23, 16384
  v_mfma_f32_16x16x32_bf16 v[20:23], v[96:99], v[4:7], 0
  v_mfma_f32_16x16x32_bf16 v[20:23], v[100:103], v[8:11], v[20:23]
  v_mfma_f32_16x16x32_bf16 v[20:23], v[104:107], v[12:15], v[20:23]
  v_mfma_f32_16x16x32_bf16 v[20:23], v[108:111], v[16:19], v[20:23]
  s_cbranch_execz L_sk14
  buffer_load_dwordx4 v[96:99], v2, s[4:7], s23 offen offset:0 nt
  buffer_load_dwordx4 v[100:103], v2, s[4:7], s23 offen offset:64 nt
  buffer_load_dwordx4 v[104:107], v2, s[4:7], s23 offen offset:128 nt
  buffer_load_dwordx4 v[108:111], v2, s[4:7], s23 offen offset:192 nt
L_sk14:
  s_nop 2
  v_max3_f32 v26, v20, v21, v22
  v_max_f32 v26, v26, v23
  v_mov_b32 v27, v26
  s_nop 1
  v_permlane32_swap_b32 v26, v27
  v_max_f32 v26, v26, v27
  v_mov_b32 v27, v26
  s_nop 1
  v_permlane16_swap_b32 v26, v27
  v_max_f32 v26, v26, v27
  v_mul_f32 v26, s25, v26
  v_max_f32 v26, v24, v26
  v_sub_f32 v62, v24, v26
  v_fma_f32 v20, v20, s25, -v26
  v_fma_f32 v21, v21, s25, -v26
  v_fma_f32 v22, v22, s25, -v26
  v_fma_f32 v23, v23, s25, -v26
  v_exp_f32 v62, v62
  v_exp_f32 v20, v20
  v_exp_f32 v21, v21
  v_mov_b32_dpp v58, v62 row_newbcast:0 row_mask:0x1 bank_mask:0xf
  v_exp_f32 v22, v22
  v_exp_f32 v23, v23
  v_mov_b32_dpp v58, v62 row_newbcast:4 row_mask:0x2 bank_mask:0xf
  v_mov_b32 v24, v26
  v_cvt_pk_bf16_f32 v60, v20, v21
  v_mov_b32_dpp v58, v62 row_newbcast:8 row_mask:0x4 bank_mask:0xf
  v_cvt_pk_bf16_f32 v61, v22, v23
  v_add_f32 v27, v20, v21
  v_mov_b32_dpp v58, v62 row_newbcast:12 row_mask:0x8 bank_mask:0xf
  v_add_f32 v26, v22, v23
  v_perm_b32 v38, v60, v60, v54
  v_perm_b32 v39, v60, v60, v56
  v_perm_b32 v42, v60, v60, v55
  v_perm_b32 v43, v60, v60, v57
  v_perm_b32 v46, v61, v61, v54
  v_perm_b32 v47, v61, v61, v56
  v_perm_b32 v50, v61, v61, v55
  v_perm_b32 v51, v61, v61, v57
  v_add_f32 v27, v27, v26
  v_pk_mul_f32 v[28:29], v[28:29], v[58:59] op_sel_hi:[1,0]
  v_pk_mul_f32 v[30:31], v[30:31], v[58:59] op_sel_hi:[1,0]
  v_pk_mul_f32 v[32:33], v[32:33], v[58:59] op_sel_hi:[1,0]
  v_pk_mul_f32 v[34:35], v[34:35], v[58:59] op_sel_hi:[1,0]
  v_fma_f32 v25, v25, v62, v27
  v_mfma_f32_16x16x32_bf16 v[28:31], v[38:41], v[112:115], v[28:31]
  v_mfma_f32_16x16x32_bf16 v[32:35], v[36:39], v[112:115], v[32:35]
  v_mfma_f32_16x16x32_bf16 v[28:31], v[42:45], v[116:119], v[28:31]
  v_mfma_f32_16x16x32_bf16 v[32:35], v[40:43], v[116:119], v[32:35]
  v_mfma_f32_16x16x32_bf16 v[28:31], v[46:49], v[120:123], v[28:31]
  v_mfma_f32_16x16x32_bf16 v[32:35], v[44:47], v[120:123], v[32:35]
  v_mfma_f32_16x16x32_bf16 v[28:31], v[50:53], v[124:127], v[28:31]
  v_mfma_f32_16x16x32_bf16 v[32:35], v[48:51], v[124:127], v[32:35]
  s_cbranch_execz L_sk15
  buffer_load_dwordx4 v[112:115], v3, s[8:11], s23 offen offset:0 nt
  buffer_load_dwordx4 v[116:119], v3, s[8:11], s23 offen offset:1024 nt
  buffer_load_dwordx4 v[120:123], v3, s[8:11], s23 offen offset:2048 nt
  buffer_load_dwordx4 v[124:127], v3, s[8:11], s23 offen offset:3072 nt
L_sk15:
  s_add_u32 s23, s23, 16384
  v_mfma_f32_16x16x32_bf16 v[20:23], v[128:131], v[4:7], 0
  v_mfma_f32_16x16x32_bf16 v[20:23], v[132:135], v[8:11], v[20:23]
  v_mfma_f32_16x16x32_bf16 v[20:23], v[136:139], v[12:15], v[20:23]
  v_mfma_f32_16x16x32_bf16 v[20:23], v[140:143], v[16:19], v[20:23]
  s_nop 7
  v_max3_f32 v26, v20, v21, v22
  v_max_f32 v26, v26, v23
  v_mov_b32 v27, v26
  s_nop 1
  v_permlane32_swap_b32 v26, v27
  v_max_f32 v26, v26, v27
  v_mov_b32 v27, v26
  s_nop 1
  v_permlane16_swap_b32 v26, v27
  v_max_f32 v26, v26, v27
  v_mul_f32 v26, s25, v26
  v_max_f32 v26, v24, v26
  v_sub_f32 v62, v24, v26
  v_fma_f32 v20, v20, s25, -v26
  v_fma_f32 v21, v21, s25, -v26
  v_fma_f32 v22, v22, s25, -v26
  v_fma_f32 v23, v23, s25, -v26
  v_exp_f32 v62, v62
  v_exp_f32 v20, v20
  v_exp_f32 v21, v21
  v_mov_b32_dpp v58, v62 row_newbcast:0 row_mask:0x1 bank_mask:0xf
  v_exp_f32 v22, v22
  v_exp_f32 v23, v23
  v_mov_b32_dpp v58, v62 row_newbcast:4 row_mask:0x2 bank_mask:0xf
  v_mov_b32 v24, v26
  v_cvt_pk_bf16_f32 v60, v20, v21
  v_mov_b32_dpp v58, v62 row_newbcast:8 row_mask:0x4 bank_mask:0xf
  v_cvt_pk_bf16_f32 v61, v22, v23
  v_add_f32 v27, v20, v21
  v_mov_b32_dpp v58, v62 row_newbcast:12 row_mask:0x8 bank_mask:0xf
  v_add_f32 v26, v22, v23
  v_perm_b32 v38, v60, v60, v54
  v_perm_b32 v39, v60, v60, v56
  v_perm_b32 v42, v60, v60, v55
  v_perm_b32 v43, v60, v60, v57
  v_perm_b32 v46, v61, v61, v54
  v_perm_b32 v47, v61, v61, v56
  v_perm_b32 v50, v61, v61, v55
  v_perm_b32 v51, v61, v61, v57
  v_add_f32 v27, v27, v26
  v_pk_mul_f32 v[28:29], v[28:29], v[58:59] op_sel_hi:[1,0]
  v_pk_mul_f32 v[30:31], v[30:31], v[58:59] op_sel_hi:[1,0]
  v_pk_mul_f32 v[32:33], v[32:33], v[58:59] op_sel_hi:[1,0]
  v_pk_mul_f32 v[34:35], v[34:35], v[58:59] op_sel_hi:[1,0]
  v_fma_f32 v25, v25, v62, v27
  v_mfma_f32_16x16x32_bf16 v[28:31], v[38:41], v[144:147], v[28:31]
  v_mfma_f32_16x16x32_bf16 v[32:35], v[36:39], v[144:147], v[32:35]
  v_mfma_f32_16x16x32_bf16 v[28:31], v[42:45], v[148:151], v[28:31]
  v_mfma_f32_16x16x32_bf16 v[32:35], v[40:43], v[148:151], v[32:35]
  v_mfma_f32_16x16x32_bf16 v[28:31], v[46:49], v[152:155], v[28:31]
  v_mfma_f32_16x16x32_bf16 v[32:35], v[44:47], v[152:155], v[32:35]
  v_mfma_f32_16x16x32_bf16 v[28:31], v[50:53], v[156:159], v[28:31]
  v_mfma_f32_16x16x32_bf16 v[32:35], v[48:51], v[156:159], v[32:35]
  v_mfma_f32_16x16x32_bf16 v[20:23], v[160:163], v[4:7], 0
  v_mfma_f32_16x16x32_bf16 v[20:23], v[164:167], v[8:11], v[20:23]
  v_mfma_f32_16x16x32_bf16 v[20:23], v[168:171], v[12:15], v[20:23]
  v_mfma_f32_16x16x32_bf16 v[20:23], v[172:175], v[16:19], v[20:23]
  s_nop 7
  v_max3_f32 v26, v20, v21, v22
  v_max_f32 v26, v26, v23
  v_mov_b32 v27, v26
  s_nop 1
  v_permlane32_swap_b32 v26, v27
  v_max_f32 v26, v26, v27
  v_mov_b32 v27, v26
  s_nop 1
  v_permlane16_swap_b32 v26, v27
  v_max_f32 v26, v26, v27
  v_mul_f32 v26, s25, v26
  v_max_f32 v26, v24, v26
  v_sub_f32 v62, v24, v26
  v_fma_f32 v20, v20, s25, -v26
  v_fma_f32 v21, v21, s25, -v26
  v_fma_f32 v22, v22, s25, -v26
  v_fma_f32 v23, v23, s25, -v26
  v_exp_f32 v62, v62
  v_exp_f32 v20, v20
  v_exp_f32 v21, v21
  v_mov_b32_dpp v58, v62 row_newbcast:0 row_mask:0x1 bank_mask:0xf
  v_exp_f32 v22, v22
  v_exp_f32 v23, v23
  v_mov_b32_dpp v58, v62 row_newbcast:4 row_mask:0x2 bank_mask:0xf
  v_mov_b32 v24, v26
  v_cvt_pk_bf16_f32 v60, v20, v21
  v_mov_b32_dpp v58, v62 row_newbcast:8 row_mask:0x4 bank_mask:0xf
  v_cvt_pk_bf16_f32 v61, v22, v23
  v_add_f32 v27, v20, v21
  v_mov_b32_dpp v58, v62 row_newbcast:12 row_mask:0x8 bank_mask:0xf
  v_add_f32 v26, v22, v23
  v_perm_b32 v38, v60, v60, v54
  v_perm_b32 v39, v60, v60, v56
  v_perm_b32 v42, v60, v60, v55
  v_perm_b32 v43, v60, v60, v57
  v_perm_b32 v46, v61, v61, v54
  v_perm_b32 v47, v61, v61, v56
  v_perm_b32 v50, v61, v61, v55
  v_perm_b32 v51, v61, v61, v57
  v_add_f32 v27, v27, v26
  v_pk_mul_f32 v[28:29], v[28:29], v[58:59] op_sel_hi:[1,0]
  v_pk_mul_f32 v[30:31], v[30:31], v[58:59] op_sel_hi:[1,0]
  v_pk_mul_f32 v[32:33], v[32:33], v[58:59] op_sel_hi:[1,0]
  v_pk_mul_f32 v[34:35], v[34:35], v[58:59] op_sel_hi:[1,0]
  v_fma_f32 v25, v25, v62, v27
  v_mfma_f32_16x16x32_bf16 v[28:31], v[38:41], v[176:179], v[28:31]
  v_mfma_f32_16x16x32_bf16 v[32:35], v[36:39], v[176:179], v[32:35]
  v_mfma_f32_16x16x32_bf16 v[28:31], v[42:45], v[180:183], v[28:31]
  v_mfma_f32_16x16x32_bf16 v[32:35], v[40:43], v[180:183], v[32:35]
  v_mfma_f32_16x16x32_bf16 v[28:31], v[46:49], v[184:187], v[28:31]
  v_mfma_f32_16x16x32_bf16 v[32:35], v[44:47], v[184:187], v[32:35]
  v_mfma_f32_16x16x32_bf16 v[28:31], v[50:53], v[188:191], v[28:31]
  v_mfma_f32_16x16x32_bf16 v[32:35], v[48:51], v[188:191], v[32:35]
  s_waitcnt vmcnt(28)
  v_mfma_f32_16x16x32_bf16 v[20:23], v[192:195], v[4:7], 0
  v_mfma_f32_16x16x32_bf16 v[20:23], v[196:199], v[8:11], v[20:23]
  v_mfma_f32_16x16x32_bf16 v[20:23], v[200:203], v[12:15], v[20:23]
  v_mfma_f32_16x16x32_bf16 v[20:23], v[204:207], v[16:19], v[20:23]
  s_nop 7
  v_max3_f32 v26, v20, v21, v22
  v_max_f32 v26, v26, v23
  v_mov_b32 v27, v26
  s_nop 1
  v_permlane32_swap_b32 v26, v27
  v_max_f32 v26, v26, v27
  v_mov_b32 v27, v26
  s_nop 1
  v_permlane16_swap_b32 v26, v27
  v_max_f32 v26, v26, v27
  v_mul_f32 v26, s25, v26
  v_max_f32 v26, v24, v26
  v_sub_f32 v62, v24, v26
  v_fma_f32 v20, v20, s25, -v26
  v_fma_f32 v21, v21, s25, -v26
  v_fma_f32 v22, v22, s25, -v26
  v_fma_f32 v23, v23, s25, -v26
  v_exp_f32 v62, v62
  v_exp_f32 v20, v20
  v_exp_f32 v21, v21
  v_mov_b32_dpp v58, v62 row_newbcast:0 row_mask:0x1 bank_mask:0xf
  v_exp_f32 v22, v22
  v_exp_f32 v23, v23
  v_mov_b32_dpp v58, v62 row_newbcast:4 row_mask:0x2 bank_mask:0xf
  v_mov_b32 v24, v26
  v_cvt_pk_bf16_f32 v60, v20, v21
  v_mov_b32_dpp v58, v62 row_newbcast:8 row_mask:0x4 bank_mask:0xf
  v_cvt_pk_bf16_f32 v61, v22, v23
  v_add_f32 v27, v20, v21
  v_mov_b32_dpp v58, v62 row_newbcast:12 row_mask:0x8 bank_mask:0xf
  v_add_f32 v26, v22, v23
  v_perm_b32 v38, v60, v60, v54
  v_perm_b32 v39, v60, v60, v56
  v_perm_b32 v42, v60, v60, v55
  v_perm_b32 v43, v60, v60, v57
  v_perm_b32 v46, v61, v61, v54
  v_perm_b32 v47, v61, v61, v56
  v_perm_b32 v50, v61, v61, v55
  v_perm_b32 v51, v61, v61, v57
  v_add_f32 v27, v27, v26
  v_pk_mul_f32 v[28:29], v[28:29], v[58:59] op_sel_hi:[1,0]
  v_pk_mul_f32 v[30:31], v[30:31], v[58:59] op_sel_hi:[1,0]
  v_pk_mul_f32 v[32:33], v[32:33], v[58:59] op_sel_hi:[1,0]
  v_pk_mul_f32 v[34:35], v[34:35], v[58:59] op_sel_hi:[1,0]
  v_fma_f32 v25, v25, v62, v27
  s_waitcnt vmcnt(24)
  v_mfma_f32_16x16x32_bf16 v[28:31], v[38:41], v[208:211], v[28:31]
  v_mfma_f32_16x16x32_bf16 v[32:35], v[36:39], v[208:211], v[32:35]
  v_mfma_f32_16x16x32_bf16 v[28:31], v[42:45], v[212:215], v[28:31]
  v_mfma_f32_16x16x32_bf16 v[32:35], v[40:43], v[212:215], v[32:35]
  v_mfma_f32_16x16x32_bf16 v[28:31], v[46:49], v[216:219], v[28:31]
  v_mfma_f32_16x16x32_bf16 v[32:35], v[44:47], v[216:219], v[32:35]
  v_mfma_f32_16x16x32_bf16 v[28:31], v[50:53], v[220:223], v[28:31]
  v_mfma_f32_16x16x32_bf16 v[32:35], v[48:51], v[220:223], v[32:35]
  s_waitcnt vmcnt(20)
  v_mfma_f32_16x16x32_bf16 v[20:23], v[224:227], v[4:7], 0
  v_mfma_f32_16x16x32_bf16 v[20:23], v[228:231], v[8:11], v[20:23]
  v_mfma_f32_16x16x32_bf16 v[20:23], v[232:235], v[12:15], v[20:23]
  v_mfma_f32_16x16x32_bf16 v[20:23], v[236:239], v[16:19], v[20:23]
  s_nop 7
  v_max3_f32 v26, v20, v21, v22
  v_max_f32 v26, v26, v23
  v_mov_b32 v27, v26
  s_nop 1
  v_permlane32_swap_b32 v26, v27
  v_max_f32 v26, v26, v27
  v_mov_b32 v27, v26
  s_nop 1
  v_permlane16_swap_b32 v26, v27
  v_max_f32 v26, v26, v27
  v_mul_f32 v26, s25, v26
  v_max_f32 v26, v24, v26
  v_sub_f32 v62, v24, v26
  v_fma_f32 v20, v20, s25, -v26
  v_fma_f32 v21, v21, s25, -v26
  v_fma_f32 v22, v22, s25, -v26
  v_fma_f32 v23, v23, s25, -v26
  v_exp_f32 v62, v62
  v_exp_f32 v20, v20
  v_exp_f32 v21, v21
  v_mov_b32_dpp v58, v62 row_newbcast:0 row_mask:0x1 bank_mask:0xf
  v_exp_f32 v22, v22
  v_exp_f32 v23, v23
  v_mov_b32_dpp v58, v62 row_newbcast:4 row_mask:0x2 bank_mask:0xf
  v_mov_b32 v24, v26
  v_cvt_pk_bf16_f32 v60, v20, v21
  v_mov_b32_dpp v58, v62 row_newbcast:8 row_mask:0x4 bank_mask:0xf
  v_cvt_pk_bf16_f32 v61, v22, v23
  v_add_f32 v27, v20, v21
  v_mov_b32_dpp v58, v62 row_newbcast:12 row_mask:0x8 bank_mask:0xf
  v_add_f32 v26, v22, v23
  v_perm_b32 v38, v60, v60, v54
  v_perm_b32 v39, v60, v60, v56
  v_perm_b32 v42, v60, v60, v55
  v_perm_b32 v43, v60, v60, v57
  v_perm_b32 v46, v61, v61, v54
  v_perm_b32 v47, v61, v61, v56
  v_perm_b32 v50, v61, v61, v55
  v_perm_b32 v51, v61, v61, v57
  v_add_f32 v27, v27, v26
  v_pk_mul_f32 v[28:29], v[28:29], v[58:59] op_sel_hi:[1,0]
  v_pk_mul_f32 v[30:31], v[30:31], v[58:59] op_sel_hi:[1,0]
  v_pk_mul_f32 v[32:33], v[32:33], v[58:59] op_sel_hi:[1,0]
  v_pk_mul_f32 v[34:35], v[34:35], v[58:59] op_sel_hi:[1,0]
  v_fma_f32 v25, v25, v62, v27
  s_waitcnt vmcnt(16)
  v_mfma_f32_16x16x32_bf16 v[28:31], v[38:41], v[240:243], v[28:31]
  v_mfma_f32_16x16x32_bf16 v[32:35], v[36:39], v[240:243], v[32:35]
  v_mfma_f32_16x16x32_bf16 v[28:31], v[42:45], v[244:247], v[28:31]
  v_mfma_f32_16x16x32_bf16 v[32:35], v[40:43], v[244:247], v[32:35]
  v_mfma_f32_16x16x32_bf16 v[28:31], v[46:49], v[248:251], v[28:31]
  v_mfma_f32_16x16x32_bf16 v[32:35], v[44:47], v[248:251], v[32:35]
  v_mfma_f32_16x16x32_bf16 v[28:31], v[50:53], v[252:255], v[28:31]
  v_mfma_f32_16x16x32_bf16 v[32:35], v[48:51], v[252:255], v[32:35]
  s_nop 7
L_loop:
  s_cmp_eq_u32 s26, 0
  s_cselect_b32 s6, 0, s6
  s_cselect_b32 s10, 0, s10
  s_waitcnt vmcnt(12)
  v_mfma_f32_16x16x32_bf16 v[20:23], v[64:67], v[4:7], 0
  v_mfma_f32_16x16x32_bf16 v[20:23], v[68:71], v[8:11], v[20:23]
  v_mfma_f32_16x16x32_bf16 v[20:23], v[72:75], v[12:15], v[20:23]
  v_mfma_f32_16x16x32_bf16 v[20:23], v[76:79], v[16:19], v[20:23]
  s_cbranch_execz L_sk16
  buffer_load_dwordx4 v[128:131], v2, s[4:7], s23 offen offset:0 nt
  buffer_load_dwordx4 v[132:135], v2, s[4:7], s23 offen offset:64 nt
  buffer_load_dwordx4 v[136:139], v2, s[4:7], s23 offen offset:128 nt
  buffer_load_dwordx4 v[140:143], v2, s[4:7], s23 offen offset:192 nt
L_sk16:
  s_nop 2
  v_max3_f32 v26, v20, v21, v22
  v_max_f32 v26, v26, v23
  v_mov_b32 v27, v26
  s_nop 1
  v_permlane32_swap_b32 v26, v27
  v_max_f32 v26, v26, v27
  v_mov_b32 v27, v26
  s_nop 1
  v_permlane16_swap_b32 v26, v27
  v_max_f32 v26, v26, v27
  v_mul_f32 v26, s25, v26
  v_max_f32 v26, v24, v26
  v_sub_f32 v62, v24, v26
  v_fma_f32 v20, v20, s25, -v26
  v_fma_f32 v21, v21, s25, -v26
  v_fma_f32 v22, v22, s25, -v26
  v_fma_f32 v23, v23, s25, -v26
  v_exp_f32 v62, v62
  v_exp_f32 v20, v20
  v_exp_f32 v21, v21
  v_mov_b32_dpp v58, v62 row_newbcast:0 row_mask:0x1 bank_mask:0xf
  v_exp_f32 v22, v22
  v_exp_f32 v23, v23
  v_mov_b32_dpp v58, v62 row_newbcast:4 row_mask:0x2 bank_mask:0xf
  v_mov_b32 v24, v26
  v_cvt_pk_bf16_f32 v60, v20, v21
  v_mov_b32_dpp v58, v62 row_newbcast:8 row_mask:0x4 bank_mask:0xf
  v_cvt_pk_bf16_f32 v61, v22, v23
  v_add_f32 v27, v20, v21
  v_mov_b32_dpp v58, v62 row_newbcast:12 row_mask:0x8 bank_mask:0xf
  v_add_f32 v26, v22, v23
  v_perm_b32 v38, v60, v60, v54
  v_perm_b32 v39, v60, v60, v56
  v_perm_b32 v42, v60, v60, v55
  v_perm_b32 v43, v60, v60, v57
  v_perm_b32 v46, v61, v61, v54
  v_perm_b32 v47, v61, v61, v56
  v_perm_b32 v50, v61, v61, v55
  v_perm_b32 v51, v61, v61, v57
  v_add_f32 v27, v27, v26
  v_pk_mul_f32 v[28:29], v[28:29], v[58:59] op_sel_hi:[1,0]
  v_pk_mul_f32 v[30:31], v[30:31], v[58:59] op_sel_hi:[1,0]
  v_pk_mul_f32 v[32:33], v[32:33], v[58:59] op_sel_hi:[1,0]
  v_pk_mul_f32 v[34:35], v[34:35], v[58:59] op_sel_hi:[1,0]
  v_fma_f32 v25, v25, v62, v27
  s_waitcnt vmcnt(12)
  s_cbranch_execz L_sk17
  buffer_load_dwordx4 v[144:147], v3, s[8:11], s23 offen offset:0 nt
  buffer_load_dwordx4 v[148:151], v3, s[8:11], s23 offen offset:1024 nt
  buffer_load_dwordx4 v[152:155], v3, s[8:11], s23 offen offset:2048 nt
  buffer_load_dwordx4 v[156:159], v3, s[8:11], s23 offen offset:3072 nt
L_sk17:
  s_add_u32 s23, s23, 16384
  v_mfma_f32_16x16x32_bf16 v[28:31], v[38:41], v[80:83], v[28:31]
  v_mfma_f32_16x16x32_bf16 v[32:35], v[36:39], v[80:83], v[32:35]
  v_mfma_f32_16x16x32_bf16 v[28:31], v[42:45], v[84:87], v[28:31]
  v_mfma_f32_16x16x32_bf16 v[32:35], v[40:43], v[84:87], v[32:35]
  v_mfma_f32_16x16x32_bf16 v[28:31], v[46:49], v[88:91], v[28:31]
  v_mfma_f32_16x16x32_bf16 v[32:35], v[44:47], v[88:91], v[32:35]
  v_mfma_f32_16x16x32_bf16 v[28:31], v[50:53], v[92:95], v[28:31]
  v_mfma_f32_16x16x32_bf16 v[32:35], v[48:51], v[92:95], v[32:35]
  s_waitcnt vmcnt(12)
  v_mfma_f32_16x16x32_bf16 v[20:23], v[96:99], v[4:7], 0
  v_mfma_f32_16x16x32_bf16 v[20:23], v[100:103], v[8:11], v[20:23]
  v_mfma_f32_16x16x32_bf16 v[20:23], v[104:107], v[12:15], v[20:23]
  v_mfma_f32_16x16x32_bf16 v[20:23], v[108:111], v[16:19], v[20:23]
  s_cbranch_execz L_sk18
  buffer_load_dwordx4 v[64:67], v2, s[4:7], s23 offen offset:0 nt
  buffer_load_dwordx4 v[68:71], v2, s[4:7], s23 offen offset:64 nt
  buffer_load_dwordx4 v[72:75], v2, s[4:7], s23 offen offset:128 nt
  buffer_load_dwordx4 v[76:79], v2, s[4:7], s23 offen offset:192 nt
L_sk18:
  s_nop 2
  v_max3_f32 v26, v20, v21, v22
  v_max_f32 v26, v26, v23
  v_mov_b32 v27, v26
  s_nop 1
  v_permlane32_swap_b32 v26, v27
  v_max_f32 v26, v26, v27
  v_mov_b32 v27, v26
  s_nop 1
  v_permlane16_swap_b32 v26, v27
  v_max_f32 v26, v26, v27
  v_mul_f32 v26, s25, v26
  v_max_f32 v26, v24, v26
  v_sub_f32 v62, v24, v26
  v_fma_f32 v20, v20, s25, -v26
  v_fma_f32 v21, v21, s25, -v26
  v_fma_f32 v22, v22, s25, -v26
  v_fma_f32 v23, v23, s25, -v26
  v_exp_f32 v62, v62
  v_exp_f32 v20, v20
  v_exp_f32 v21, v21
  v_mov_b32_dpp v58, v62 row_newbcast:0 row_mask:0x1 bank_mask:0xf
  v_exp_f32 v22, v22
  v_exp_f32 v23, v23
  v_mov_b32_dpp v58, v62 row_newbcast:4 row_mask:0x2 bank_mask:0xf
  v_mov_b32 v24, v26
  v_cvt_pk_bf16_f32 v60, v20, v21
  v_mov_b32_dpp v58, v62 row_newbcast:8 row_mask:0x4 bank_mask:0xf
  v_cvt_pk_bf16_f32 v61, v22, v23
  v_add_f32 v27, v20, v21
  v_mov_b32_dpp v58, v62 row_newbcast:12 row_mask:0x8 bank_mask:0xf
  v_add_f32 v26, v22, v23
  v_perm_b32 v38, v60, v60, v54
  v_perm_b32 v39, v60, v60, v56
  v_perm_b32 v42, v60, v60, v55
  v_perm_b32 v43, v60, v60, v57
  v_perm_b32 v46, v61, v61, v54
  v_perm_b32 v47, v61, v61, v56
  v_perm_b32 v50, v61, v61, v55
  v_perm_b32 v51, v61, v61, v57
  v_add_f32 v27, v27, v26
  v_pk_mul_f32 v[28:29], v[28:29], v[58:59] op_sel_hi:[1,0]
  v_pk_mul_f32 v[30:31], v[30:31], v[58:59] op_sel_hi:[1,0]
  v_pk_mul_f32 v[32:33], v[32:33], v[58:59] op_sel_hi:[1,0]
  v_pk_mul_f32 v[34:35], v[34:35], v[58:59] op_sel_hi:[1,0]
  v_fma_f32 v25, v25, v62, v27
  s_waitcnt vmcnt(12)
  s_cbranch_execz L_sk19
  buffer_load_dwordx4 v[80:83], v3, s[8:11], s23 offen offset:0 nt
  buffer_load_dwordx4 v[84:87], v3, s[8:11], s23 offen offset:1024 nt
  buffer_load_dwordx4 v[88:91], v3, s[8:11], s23 offen offset:2048 nt
  buffer_load_dwordx4 v[92:95], v3, s[8:11], s23 offen offset:3072 nt
L_sk19:
  s_add_u32 s23, s23, 16384
  v_mfma_f32_16x16x32_bf16 v[28:31], v[38:41], v[112:115], v[28:31]
  v_mfma_f32_16x16x32_bf16 v[32:35], v[36:39], v[112:115], v[32:35]
  v_mfma_f32_16x16x32_bf16 v[28:31], v[42:45], v[116:119], v[28:31]
  v_mfma_f32_16x16x32_bf16 v[32:35], v[40:43], v[116:119], v[32:35]
  v_mfma_f32_16x16x32_bf16 v[28:31], v[46:49], v[120:123], v[28:31]
  v_mfma_f32_16x16x32_bf16 v[32:35], v[44:47], v[120:123], v[32:35]
  v_mfma_f32_16x16x32_bf16 v[28:31], v[50:53], v[124:127], v[28:31]
  v_mfma_f32_16x16x32_bf16 v[32:35], v[48:51], v[124:127], v[32:35]
  s_cmp_eq_u32 s26, 0
  s_nop 5
  s_cbranch_scc1 L_epi
  s_waitcnt vmcnt(12)
  v_mfma_f32_16x16x32_bf16 v[20:23], v[128:131], v[4:7], 0
  v_mfma_f32_16x16x32_bf16 v[20:23], v[132:135], v[8:11], v[20:23]
  v_mfma_f32_16x16x32_bf16 v[20:23], v[136:139], v[12:15], v[20:23]
  v_mfma_f32_16x16x32_bf16 v[20:23], v[140:143], v[16:19], v[20:23]
  s_cbranch_execz L_sk20
  buffer_load_dwordx4 v[96:99], v2, s[4:7], s23 offen offset:0 nt
  buffer_load_dwordx4 v[100:103], v2, s[4:7], s23 offen offset:64 nt
  buffer_load_dwordx4 v[104:107], v2, s[4:7], s23 offen offset:128 nt
  buffer_load_dwordx4 v[108:111], v2, s[4:7], s23 offen offset:192 nt
L_sk20:
  s_nop 2
  v_max3_f32 v26, v20, v21, v22
  v_max_f32 v26, v26, v23
  v_mov_b32 v27, v26
  s_nop 1
  v_permlane32_swap_b32 v26, v27
  v_max_f32 v26, v26, v27
  v_mov_b32 v27, v26
  s_nop 1
  v_permlane16_swap_b32 v26, v27
  v_max_f32 v26, v26, v27
  v_mul_f32 v26, s25, v26
  v_max_f32 v26, v24, v26
  v_sub_f32 v62, v24, v26
  v_fma_f32 v20, v20, s25, -v26
  v_fma_f32 v21, v21, s25, -v26
  v_fma_f32 v22, v22, s25, -v26
  v_fma_f32 v23, v23, s25, -v26
  v_exp_f32 v62, v62
  v_exp_f32 v20, v20
  v_exp_f32 v21, v21
  v_mov_b32_dpp v58, v62 row_newbcast:0 row_mask:0x1 bank_mask:0xf
  v_exp_f32 v22, v22
  v_exp_f32 v23, v23
  v_mov_b32_dpp v58, v62 row_newbcast:4 row_mask:0x2 bank_mask:0xf
  v_mov_b32 v24, v26
  v_cvt_pk_bf16_f32 v60, v20, v21
  v_mov_b32_dpp v58, v62 row_newbcast:8 row_mask:0x4 bank_mask:0xf
  v_cvt_pk_bf16_f32 v61, v22, v23
  v_add_f32 v27, v20, v21
  v_mov_b32_dpp v58, v62 row_newbcast:12 row_mask:0x8 bank_mask:0xf
  v_add_f32 v26, v22, v23
  v_perm_b32 v38, v60, v60, v54
  v_perm_b32 v39, v60, v60, v56
  v_perm_b32 v42, v60, v60, v55
  v_perm_b32 v43, v60, v60, v57
  v_perm_b32 v46, v61, v61, v54
  v_perm_b32 v47, v61, v61, v56
  v_perm_b32 v50, v61, v61, v55
  v_perm_b32 v51, v61, v61, v57
  v_add_f32 v27, v27, v26
  v_pk_mul_f32 v[28:29], v[28:29], v[58:59] op_sel_hi:[1,0]
  v_pk_mul_f32 v[30:31], v[30:31], v[58:59] op_sel_hi:[1,0]
  v_pk_mul_f32 v[32:33], v[32:33], v[58:59] op_sel_hi:[1,0]
  v_pk_mul_f32 v[34:35], v[34:35], v[58:59] op_sel_hi:[1,0]
  v_fma_f32 v25, v25, v62, v27
  s_waitcnt vmcnt(12)
  s_cbranch_execz L_sk21
  buffer_load_dwordx4 v[112:115], v3, s[8:11], s23 offen offset:0 nt
  buffer_load_dwordx4 v[116:119], v3, s[8:11], s23 offen offset:1024 nt
  buffer_load_dwordx4 v[120:123], v3, s[8:11], s23 offen offset:2048 nt
  buffer_load_dwordx4 v[124:127], v3, s[8:11], s23 offen offset:3072 nt
L_sk21:
  s_add_u32 s23, s23, 16384
  v_mfma_f32_16x16x32_bf16 v[28:31], v[38:41], v[144:147], v[28:31]
  v_mfma_f32_16x16x32_bf16 v[32:35], v[36:39], v[144:147], v[32:35]
  v_mfma_f32_16x16x32_bf16 v[28:31], v[42:45], v[148:151], v[28:31]
  v_mfma_f32_16x16x32_bf16 v[32:35], v[40:43], v[148:151], v[32:35]
  v_mfma_f32_16x16x32_bf16 v[28:31], v[46:49], v[152:155], v[28:31]
  v_mfma_f32_16x16x32_bf16 v[32:35], v[44:47], v[152:155], v[32:35]
  v_mfma_f32_16x16x32_bf16 v[28:31], v[50:53], v[156:159], v[28:31]
  v_mfma_f32_16x16x32_bf16 v[32:35], v[48:51], v[156:159], v[32:35]
  s_sub_u32 s26, s26, 1
  s_nop 5
  s_branch L_loop
L_epi:
  v_mov_b32 v27, v25
  ds_write_b128 v0, v[28:31]
  s_nop 0
  v_permlane32_swap_b32 v25, v27
  ds_write_b128 v0, v[32:35] offset:16
  v_add_f32 v25, v25, v27
  v_mov_b32 v27, v25
  s_lshl_b32 s24, s3, 5
  s_add_u32 s24, s24, 9216
  v_permlane16_swap_b32 v25, v27
  v_add_f32 v25, v25, v27
  v_mov_b32 v26, s24
  ds_write_b64 v1, v[24:25]
  v_mov_b32 v45, s21
  s_mov_b32 s56, 0xaaaaaaaa
  s_mov_b32 s57, 0xaaaaaaaa
  s_mov_b32 s58, 0x07060302
  s_mov_b32 s59, 0x05040100
  s_waitcnt lgkmcnt(0)
  s_cbranch_execz L_sk22
  s_barrier
L_sk22:
  ds_read_b128 v[4:7], v26
  ds_read_b128 v[8:11], v26 offset:16
  ds_read_b64 v[12:13], v59 offset:0
  ds_read_b64 v[14:15], v59 offset:2048
  ds_read_b64 v[16:17], v59 offset:4096
  ds_read_b64 v[18:19], v59 offset:6144
  s_waitcnt lgkmcnt(4)
  v_max3_f32 v44, v4, v6, v8
  v_max_f32 v44, v44, v10
  v_sub_f32 v4, v4, v44
  v_sub_f32 v6, v6, v44
  v_sub_f32 v8, v8, v44
  v_sub_f32 v10, v10, v44
  v_exp_f32 v4, v4
  v_exp_f32 v6, v6
  v_exp_f32 v8, v8
  v_exp_f32 v10, v10
  v_mul_f32 v46, v4, v5
  v_fmac_f32 v46, v6, v7
  v_fmac_f32 v46, v8, v9
  v_fmac_f32 v46, v10, v11
  v_cndmask_b32 v44, v44, v46, s[56:57]
  s_waitcnt lgkmcnt(0)
  v_mul_f32 v20, v4, v12
  v_mul_f32 v22, v4, v13
  v_perm_b32 v21, v45, v44, s58
  v_perm_b32 v23, v45, v44, s59
  v_fmac_f32 v20, v6, v14
  v_fmac_f32 v22, v6, v15
  v_fmac_f32 v20, v8, v16
  v_fmac_f32 v22, v8, v17
  v_fmac_f32 v20, v10, v18
  v_fmac_f32 v22, v10, v19
  s_cbranch_execz L_hinit
  buffer_store_dwordx4 v[20:23], v63, s[12:15], s27 offen sc1
L_exit:
  s_endpgm
.p2align 6
L_h0b:
  v_and_b32 v8, 1, v0
  v_bfe_u32 v9, v0, 1, 2
  v_lshlrev_b32 v8, 4, v8
  v_mov_b32 v10, 0xffff
  v_cmp_eq_u32 s[56:57], 0, v9
  v_cmp_eq_u32 s[58:59], 1, v9
  v_cmp_eq_u32 s[62:63], 2, v9
  v_cmp_eq_u32 vcc, 3, v9
  v_lshlrev_b32 v8, v8, v10
  v_cndmask_b32 v4, 0, v8, s[56:57]
  v_cndmask_b32 v5, 0, v8, s[58:59]
  v_cndmask_b32 v6, 0, v8, s[62:63]
  v_cndmask_b32 v7, 0, v8, vcc
  v_lshrrev_b32 v13, 5, v0
  v_lshlrev_b32 v13, 13, v13
  v_and_b32 v14, 31, v0
  v_lshl_or_b32 v13, v14, 4, v13
  s_lshl_b32 s29, s25, 14
  s_lshl_b32 s30, s24, 10
  s_add_u32 s29, s29, s30
  s_add_u32 s29, s29, 65536
  s_waitcnt lgkmcnt(0)
  s_mul_i32 s31, s31, 0x9E3779B1
  s_add_u32 s31, s31, 0x7F4A7C15
  v_mov_b32 v57, s31
  v_mov_b32 v59, s31
  v_mov_b32 v61, s31
  v_mov_b32 v63, s31
  s_waitcnt vmcnt(18)
  v_lshlrev_b32 v128, 16, v32
  v_and_b32 v129, 0xffff0000, v32
  v_lshlrev_b32 v130, 16, v33
  v_and_b32 v131, 0xffff0000, v33
  v_lshlrev_b32 v132, 16, v34
  v_and_b32 v133, 0xffff0000, v34
  v_lshlrev_b32 v134, 16, v35
  v_and_b32 v135, 0xffff0000, v35
  v_lshlrev_b32 v136, 16, v36
  v_and_b32 v137, 0xffff0000, v36
  v_lshlrev_b32 v138, 16, v37
  v_and_b32 v139, 0xffff0000, v37
  v_lshlrev_b32 v140, 16, v38
  v_and_b32 v141, 0xffff0000, v38
  v_lshlrev_b32 v142, 16, v39
  v_and_b32 v143, 0xffff0000, v39
  v_pk_add_f32 v[48:49], v[128:129], v[130:131]
  v_pk_add_f32 v[50:51], v[132:133], v[134:135]
  v_pk_add_f32 v[48:49], v[48:49], v[136:137]
  v_pk_add_f32 v[50:51], v[50:51], v[138:139]
  v_pk_add_f32 v[48:49], v[48:49], v[140:141]
  v_pk_add_f32 v[50:51], v[50:51], v[142:143]
  v_pk_add_f32 v[48:49], v[48:49], v[50:51]
  v_add_f32 v48, v48, v49
  s_nop 1
  v_add_f32_dpp v48, v48, v48 quad_perm:[1,0,3,2] row_mask:0xf bank_mask:0xf
  s_nop 1
  v_add_f32_dpp v48, v48, v48 quad_perm:[2,3,0,1] row_mask:0xf bank_mask:0xf
  s_nop 1
  v_add_f32_dpp v48, v48, v48 row_half_mirror row_mask:0xf bank_mask:0xf
  v_mov_b32 v49, v48
  s_nop 1
  v_permlane16_swap_b32 v48, v49
  v_add_f32 v48, v48, v49
  v_mov_b32 v49, v48
  s_nop 1
  v_permlane32_swap_b32 v48, v49
  v_add_f32 v48, v48, v49
  v_mul_f32 v48, 0x3b000000, v48
  v_pk_add_f32 v[128:129], v[128:129], v[48:49] op_sel_hi:[1,0] neg_lo:[0,1] neg_hi:[0,1]
  v_pk_add_f32 v[130:131], v[130:131], v[48:49] op_sel_hi:[1,0] neg_lo:[0,1] neg_hi:[0,1]
  v_pk_add_f32 v[132:133], v[132:133], v[48:49] op_sel_hi:[1,0] neg_lo:[0,1] neg_hi:[0,1]
  v_pk_add_f32 v[134:135], v[134:135], v[48:49] op_sel_hi:[1,0] neg_lo:[0,1] neg_hi:[0,1]
  v_pk_add_f32 v[136:137], v[136:137], v[48:49] op_sel_hi:[1,0] neg_lo:[0,1] neg_hi:[0,1]
  v_pk_add_f32 v[138:139], v[138:139], v[48:49] op_sel_hi:[1,0] neg_lo:[0,1] neg_hi:[0,1]
  v_pk_add_f32 v[140:141], v[140:141], v[48:49] op_sel_hi:[1,0] neg_lo:[0,1] neg_hi:[0,1]
  v_pk_add_f32 v[142:143], v[142:143], v[48:49] op_sel_hi:[1,0] neg_lo:[0,1] neg_hi:[0,1]
  v_pk_mul_f32 v[50:51], v[128:129], v[128:129]
  v_pk_mul_f32 v[52:53], v[130:131], v[130:131]
  v_pk_fma_f32 v[50:51], v[132:133], v[132:133], v[50:51]
  v_pk_fma_f32 v[52:53], v[134:135], v[134:135], v[52:53]
  v_pk_fma_f32 v[50:51], v[136:137], v[136:137], v[50:51]
  v_pk_fma_f32 v[52:53], v[138:139], v[138:139], v[52:53]
  v_pk_fma_f32 v[50:51], v[140:141], v[140:141], v[50:51]
  v_pk_fma_f32 v[52:53], v[142:143], v[142:143], v[52:53]
  v_pk_add_f32 v[50:51], v[50:51], v[52:53]
  v_add_f32 v50, v50, v51
  s_nop 1
  v_add_f32_dpp v50, v50, v50 quad_perm:[1,0,3,2] row_mask:0xf bank_mask:0xf
  s_nop 1
  v_add_f32_dpp v50, v50, v50 quad_perm:[2,3,0,1] row_mask:0xf bank_mask:0xf
  s_nop 1
  v_add_f32_dpp v50, v50, v50 row_half_mirror row_mask:0xf bank_mask:0xf
  v_mov_b32 v51, v50
  s_nop 1
  v_permlane16_swap_b32 v50, v51
  v_add_f32 v50, v50, v51
  v_mov_b32 v51, v50
  s_nop 1
  v_permlane32_swap_b32 v50, v51
  v_add_f32 v50, v50, v51
  v_mul_f32 v50, 0x3b000000, v50
  v_cvt_pk_bf16_f32 v49, v48, v50
  v_lshlrev_b32 v48, 16, v49
  v_and_b32 v50, 0xffff0000, v49
  v_add_f32 v50, 0x3727c5ac, v50
  v_cvt_pk_bf16_f32 v50, v50, v50
  v_and_b32 v50, 0xffff0000, v50
  v_sqrt_f32 v50, v50
  s_nop 0
  v_cvt_pk_bf16_f32 v50, v50, v50
  v_and_b32 v50, 0xffff0000, v50
  v_rcp_f32 v50, v50
  s_waitcnt vmcnt(16)
  v_lshlrev_b32 v128, 16, v40
  v_and_b32 v129, 0xffff0000, v40
  v_lshlrev_b32 v130, 16, v41
  v_and_b32 v131, 0xffff0000, v41
  v_lshlrev_b32 v132, 16, v42
  v_and_b32 v133, 0xffff0000, v42
  v_lshlrev_b32 v134, 16, v43
  v_and_b32 v135, 0xffff0000, v43
  v_lshlrev_b32 v136, 16, v44
  v_and_b32 v137, 0xffff0000, v44
  v_lshlrev_b32 v138, 16, v45
  v_and_b32 v139, 0xffff0000, v45
  v_lshlrev_b32 v140, 16, v46
  v_and_b32 v141, 0xffff0000, v46
  v_lshlrev_b32 v142, 16, v47
  v_and_b32 v143, 0xffff0000, v47
  v_pk_add_f32 v[128:129], v[128:129], v[48:49] op_sel_hi:[1,0] neg_lo:[0,1] neg_hi:[0,1]
  v_pk_add_f32 v[130:131], v[130:131], v[48:49] op_sel_hi:[1,0] neg_lo:[0,1] neg_hi:[0,1]
  v_pk_add_f32 v[132:133], v[132:133], v[48:49] op_sel_hi:[1,0] neg_lo:[0,1] neg_hi:[0,1]
  v_pk_add_f32 v[134:135], v[134:135], v[48:49] op_sel_hi:[1,0] neg_lo:[0,1] neg_hi:[0,1]
  v_pk_add_f32 v[136:137], v[136:137], v[48:49] op_sel_hi:[1,0] neg_lo:[0,1] neg_hi:[0,1]
  v_pk_add_f32 v[138:139], v[138:139], v[48:49] op_sel_hi:[1,0] neg_lo:[0,1] neg_hi:[0,1]
  v_pk_add_f32 v[140:141], v[140:141], v[48:49] op_sel_hi:[1,0] neg_lo:[0,1] neg_hi:[0,1]
  v_pk_add_f32 v[142:143], v[142:143], v[48:49] op_sel_hi:[1,0] neg_lo:[0,1] neg_hi:[0,1]
  v_cvt_pk_bf16_f32 v40, v128, v129
  v_cvt_pk_bf16_f32 v41, v130, v131
  v_cvt_pk_bf16_f32 v42, v132, v133
  v_cvt_pk_bf16_f32 v43, v134, v135
  v_cvt_pk_bf16_f32 v44, v136, v137
  v_cvt_pk_bf16_f32 v45, v138, v139
  v_cvt_pk_bf16_f32 v46, v140, v141
  v_cvt_pk_bf16_f32 v47, v142, v143
  v_lshlrev_b32 v128, 16, v40
  v_and_b32 v129, 0xffff0000, v40
  v_lshlrev_b32 v130, 16, v41
  v_and_b32 v131, 0xffff0000, v41
  v_lshlrev_b32 v132, 16, v42
  v_and_b32 v133, 0xffff0000, v42
  v_lshlrev_b32 v134, 16, v43
  v_and_b32 v135, 0xffff0000, v43
  v_lshlrev_b32 v136, 16, v44
  v_and_b32 v137, 0xffff0000, v44
  v_lshlrev_b32 v138, 16, v45
  v_and_b32 v139, 0xffff0000, v45
  v_lshlrev_b32 v140, 16, v46
  v_and_b32 v141, 0xffff0000, v46
  v_lshlrev_b32 v142, 16, v47
  v_and_b32 v143, 0xffff0000, v47
  v_pk_mul_f32 v[128:129], v[128:129], v[50:51] op_sel_hi:[1,0]
  v_pk_mul_f32 v[130:131], v[130:131], v[50:51] op_sel_hi:[1,0]
  v_pk_mul_f32 v[132:133], v[132:133], v[50:51] op_sel_hi:[1,0]
  v_pk_mul_f32 v[134:135], v[134:135], v[50:51] op_sel_hi:[1,0]
  v_pk_mul_f32 v[136:137], v[136:137], v[50:51] op_sel_hi:[1,0]
  v_pk_mul_f32 v[138:139], v[138:139], v[50:51] op_sel_hi:[1,0]
  v_pk_mul_f32 v[140:141], v[140:141], v[50:51] op_sel_hi:[1,0]
  v_pk_mul_f32 v[142:143], v[142:143], v[50:51] op_sel_hi:[1,0]
  v_cvt_pk_bf16_f32 v144, v128, v128
  v_cvt_pk_bf16_f32 v145, v129, v129
  v_cvt_pk_bf16_f32 v146, v130, v130
  v_cvt_pk_bf16_f32 v147, v131, v131
  v_cvt_pk_bf16_f32 v148, v132, v132
  v_cvt_pk_bf16_f32 v149, v133, v133
  v_cvt_pk_bf16_f32 v150, v134, v134
  v_cvt_pk_bf16_f32 v151, v135, v135
  v_cvt_pk_bf16_f32 v152, v136, v136
  v_cvt_pk_bf16_f32 v153, v137, v137
  v_cvt_pk_bf16_f32 v154, v138, v138
  v_cvt_pk_bf16_f32 v155, v139, v139
  v_cvt_pk_bf16_f32 v156, v140, v140
  v_cvt_pk_bf16_f32 v157, v141, v141
  v_cvt_pk_bf16_f32 v158, v142, v142
  v_cvt_pk_bf16_f32 v159, v143, v143
  v_and_b32 v160, v144, v4
  v_and_b32 v161, v144, v5
  v_and_b32 v162, v144, v6
  v_and_b32 v163, v144, v7
  v_and_b32 v164, v145, v4
  v_and_b32 v165, v145, v5
  v_and_b32 v166, v145, v6
  v_and_b32 v167, v145, v7
  v_and_b32 v168, v146, v4
  v_and_b32 v169, v146, v5
  v_and_b32 v170, v146, v6
  v_and_b32 v171, v146, v7
  v_and_b32 v172, v147, v4
  v_and_b32 v173, v147, v5
  v_and_b32 v174, v147, v6
  v_and_b32 v175, v147, v7
  v_and_b32 v176, v148, v4
  v_and_b32 v177, v148, v5
  v_and_b32 v178, v148, v6
  v_and_b32 v179, v148, v7
  v_and_b32 v180, v149, v4
  v_and_b32 v181, v149, v5
  v_and_b32 v182, v149, v6
  v_and_b32 v183, v149, v7
  v_and_b32 v184, v150, v4
  v_and_b32 v185, v150, v5
  v_and_b32 v186, v150, v6
  v_and_b32 v187, v150, v7
  v_and_b32 v188, v151, v4
  v_and_b32 v189, v151, v5
  v_and_b32 v190, v151, v6
  v_and_b32 v191, v151, v7
  v_and_b32 v192, v152, v4
  v_and_b32 v193, v152, v5
  v_and_b32 v194, v152, v6
  v_and_b32 v195, v152, v7
  v_and_b32 v196, v153, v4
  v_and_b32 v197, v153, v5
  v_and_b32 v198, v153, v6
  v_and_b32 v199, v153, v7
  v_and_b32 v200, v154, v4
  v_and_b32 v201, v154, v5
  v_and_b32 v202, v154, v6
  v_and_b32 v203, v154, v7
  v_and_b32 v204, v155, v4
  v_and_b32 v205, v155, v5
  v_and_b32 v206, v155, v6
  v_and_b32 v207, v155, v7
  v_and_b32 v208, v156, v4
  v_and_b32 v209, v156, v5
  v_and_b32 v210, v156, v6
  v_and_b32 v211, v156, v7
  v_and_b32 v212, v157, v4
  v_and_b32 v213, v157, v5
  v_and_b32 v214, v157, v6
  v_and_b32 v215, v157, v7
  v_and_b32 v216, v158, v4
  v_and_b32 v217, v158, v5
  v_and_b32 v218, v158, v6
  v_and_b32 v219, v158, v7
  v_and_b32 v220, v159, v4
  v_and_b32 v221, v159, v5
  v_and_b32 v222, v159, v6
  v_and_b32 v223, v159, v7
  s_waitcnt vmcnt(15)
  v_mfma_f32_16x16x32_bf16 v[48:51], v[160:163], v[64:67], 0
  s_waitcnt vmcnt(14)
  v_mfma_f32_16x16x32_bf16 v[48:51], v[164:167], v[68:71], v[48:51]
  s_waitcnt vmcnt(13)
  v_mfma_f32_16x16x32_bf16 v[48:51], v[168:171], v[72:75], v[48:51]
  s_waitcnt vmcnt(12)
  v_mfma_f32_16x16x32_bf16 v[48:51], v[172:175], v[76:79], v[48:51]
  s_waitcnt vmcnt(11)
  v_mfma_f32_16x16x32_bf16 v[48:51], v[176:179], v[80:83], v[48:51]
  s_waitcnt vmcnt(10)
  v_mfma_f32_16x16x32_bf16 v[48:51], v[180:183], v[84:87], v[48:51]
  s_waitcnt vmcnt(9)
  v_mfma_f32_16x16x32_bf16 v[48:51], v[184:187], v[88:91], v[48:51]
  s_waitcnt vmcnt(8)
  v_mfma_f32_16x16x32_bf16 v[48:51], v[188:191], v[92:95], v[48:51]
  s_waitcnt vmcnt(7)
  v_mfma_f32_16x16x32_bf16 v[48:51], v[192:195], v[96:99], v[48:51]
  s_waitcnt vmcnt(6)
  v_mfma_f32_16x16x32_bf16 v[48:51], v[196:199], v[100:103], v[48:51]
  s_waitcnt vmcnt(5)
  v_mfma_f32_16x16x32_bf16 v[48:51], v[200:203], v[104:107], v[48:51]
  s_waitcnt vmcnt(4)
  v_mfma_f32_16x16x32_bf16 v[48:51], v[204:207], v[108:111], v[48:51]
  s_waitcnt vmcnt(3)
  v_mfma_f32_16x16x32_bf16 v[48:51], v[208:211], v[112:115], v[48:51]
  s_waitcnt vmcnt(2)
  v_mfma_f32_16x16x32_bf16 v[48:51], v[212:215], v[116:119], v[48:51]
  s_waitcnt vmcnt(1)
  v_mfma_f32_16x16x32_bf16 v[48:51], v[216:219], v[120:123], v[48:51]
  s_waitcnt vmcnt(0)
  v_mfma_f32_16x16x32_bf16 v[48:51], v[220:223], v[124:127], v[48:51]
  s_nop 7
  v_mov_b32 v56, v48
  v_mov_b32 v58, v49
  v_mov_b32 v60, v50
  v_mov_b32 v62, v51
  buffer_store_dwordx4 v[56:59], v13, s[12:15], s29 offen sc1
  buffer_store_dwordx4 v[60:63], v13, s[12:15], s29 offen offset:512 sc1
  v_mov_b32 v8, 1
  v_mov_b32 v9, 13312
  ds_write_b32 v9, v8
  s_nop 0
L_hinit:
  s_mov_b64 exec, -1
  s_setprio 3
  s_sub_u32 s3, s3, 4
  s_waitcnt lgkmcnt(0)
  s_load_dword s21, s[12:13], 0
  s_mov_b32 s22, 20000
  v_bfe_u32 v1, v0, 3, 1
  v_lshrrev_b32 v2, 4, v0
  v_and_b32 v3, 15, v0
  v_lshlrev_b32 v12, 4, v0
  s_and_b32 s24, s2, 7
  s_lshr_b32 s25, s2, 3
  s_lshr_b32 s23, s2, 5
  s_lshl_b32 s23, s23, 3
  s_add_u32 s23, s23, s24
  s_lshl_b32 s28, s23, 2
  s_add_u32 s28, s28, s3
  s_lshl_b32 s29, s28, 14
  s_and_b32 s30, s25, 3
  s_lshl_b32 s31, s30, 8
  s_add_u32 s29, s29, s31
  s_add_u32 s16, s40, s29
  s_addc_u32 s17, s41, 0
  s_mov_b32 s18, 15616
  s_mov_b32 s19, 0x00020000
  v_and_b32 v15, 1, v2
  v_lshlrev_b32 v15, 13, v15
  v_lshrrev_b32 v14, 1, v2
  v_lshl_or_b32 v15, v14, 10, v15
  v_lshl_or_b32 v15, v3, 4, v15
  s_movk_i32 s26, 0x1000
  buffer_load_dwordx4 v[16:19], v15, s[16:19], 0 offen offset:0 nt
  buffer_load_dwordx4 v[20:23], v15, s[16:19], 0 offen offset:2048 nt
  buffer_load_dwordx4 v[24:27], v15, s[16:19], s26 offen offset:0 nt
  buffer_load_dwordx4 v[28:31], v15, s[16:19], s26 offen offset:2048 nt
  s_mov_b32 s4, s32
  s_mov_b32 s5, s33
  s_mov_b32 s6, 2048
  s_mov_b32 s54, 2048
  s_mov_b32 s55, 0x00020000
  v_mov_b32 v61, 0
  s_cmp_eq_u32 s3, 0
  s_cbranch_scc1 L_igate
  s_cmp_eq_u32 s3, 3
  s_cbranch_scc1 L_qw
  s_cmp_ge_u32 s2, 224
  s_cbranch_scc1 L_qw
  s_cmp_eq_u32 s3, 1
  s_cbranch_scc1 L_qw
  s_lshr_b32 s26, s24, 2
  s_lshl_b32 s27, s25, 1
  s_add_u32 s27, s27, s26
  s_lshl_b32 s29, s27, 15
  s_and_b32 s26, s24, 3
  s_lshl_b32 s26, s26, 8
  s_add_u32 s29, s29, s26
  s_add_u32 s8, s48, s29
  s_addc_u32 s9, s49, 0
  s_mov_b32 s10, 32000
  v_lshlrev_b32 v14, 4, v3
  v_lshl_or_b32 v14, v2, 13, v14
  s_movk_i32 s29, 0x1000
  buffer_load_dwordx4 v[64:67], v14, s[8:11], 0 offen offset:0 nt
  buffer_load_dwordx4 v[68:71], v14, s[8:11], 0 offen offset:1024 nt
  buffer_load_dwordx4 v[72:75], v14, s[8:11], 0 offen offset:2048 nt
  buffer_load_dwordx4 v[76:79], v14, s[8:11], 0 offen offset:3072 nt
  buffer_load_dwordx4 v[80:83], v14, s[8:11], s29 offen offset:0 nt
  buffer_load_dwordx4 v[84:87], v14, s[8:11], s29 offen offset:1024 nt
  buffer_load_dwordx4 v[88:91], v14, s[8:11], s29 offen offset:2048 nt
  buffer_load_dwordx4 v[92:95], v14, s[8:11], s29 offen offset:3072 nt
  s_lshl_b32 s29, s25, 7
  s_add_u32 s16, s46, s29
  s_addc_u32 s17, s47, 0
  s_mov_b32 s18, 128
  v_and_b32 v47, 7, v0
  v_lshlrev_b32 v47, 4, v47
  v_lshl_or_b32 v47, v1, 3, v47
  v_lshrrev_b32 v14, 5, v0
  v_lshl_or_b32 v47, v14, 2, v47
  buffer_load_dword v62, v47, s[16:19], 0 offen
  s_branch L_qw
L_imlp1:
  v_and_b32 v13, 7, v0
  v_lshl_or_b32 v14, v2, 3, v13
  v_lshlrev_b32 v14, 5, v14
  v_lshl_or_b32 v14, v1, 10, v14
  buffer_load_dwordx4 v[32:35], v14, s[4:7], 0 offen
  buffer_load_dwordx4 v[36:39], v14, s[4:7], 0 offen offset:16
  v_bfe_u32 v14, v0, 2, 1
  v_lshl_or_b32 v14, v2, 1, v14
  v_lshlrev_b32 v14, 4, v14
  v_lshl_or_b32 v14, v1, 10, v14
  s_lshl_b32 s26, s24, 7
  buffer_load_dwordx4 v[40:43], v14, s[4:7], s26 offen
  s_mul_i32 s26, s24, 229376
  s_lshl_b32 s27, s25, 7
  s_add_u32 s26, s26, s27
  s_add_u32 s8, s44, s26
  s_addc_u32 s9, s45, 0
  s_mov_b32 s10, 225920
  v_lshl_or_b32 v14, v2, 1, v1
  v_mul_u32_u24 v14, 28672, v14
  v_lshl_add_u32 v14, v13, 4, v14
  s_mov_b32 s26, 0
  buffer_load_dwordx4 v[64:67], v14, s[8:11], s26 offen offset:0 nt
  buffer_load_dwordx4 v[68:71], v14, s[8:11], s26 offen offset:3584 nt
  s_add_u32 s26, s26, 7168
  buffer_load_dwordx4 v[72:75], v14, s[8:11], s26 offen offset:0 nt
  buffer_load_dwordx4 v[76:79], v14, s[8:11], s26 offen offset:3584 nt
  s_add_u32 s26, s26, 7168
  buffer_load_dwordx4 v[80:83], v14, s[8:11], s26 offen offset:0 nt
  buffer_load_dwordx4 v[84:87], v14, s[8:11], s26 offen offset:3584 nt
  s_add_u32 s26, s26, 7168
  buffer_load_dwordx4 v[88:91], v14, s[8:11], s26 offen offset:0 nt
  buffer_load_dwordx4 v[92:95], v14, s[8:11], s26 offen offset:3584 nt
  s_branch L_qw
L_igate:
  s_bfe_u32 s26, s2, 0x20001
  s_lshl_b32 s26, s26, 7
  s_and_b32 s27, s25, 7
  s_lshl_b32 s27, s27, 4
  s_add_u32 s26, s26, s27
  s_bfe_u32 s27, s25, 0x10003
  s_lshl_b32 s27, s27, 2
  s_add_u32 s26, s26, s27
  s_lshr_b32 s27, s25, 4
  s_lshl_b32 s27, s27, 1
  s_add_u32 s26, s26, s27
  v_lshrrev_b32 v60, 5, v0
  v_and_b32 v61, 1, v0
  v_lshl_or_b32 v60, v61, 3, v60
  v_add_u32 v60, s26, v60
  v_lshlrev_b32 v60, 1, v60
  s_and_b32 s27, s2, 1
  s_lshl_b32 s27, s27, 10
  v_add_u32 v61, s27, v60
  s_mov_b32 s8, s50
  s_mov_b32 s9, s51
  s_mov_b32 s10, 1024
  buffer_load_ushort v62, v61, s[4:7], 0 offen
  buffer_load_ushort v63, v60, s[8:11], 0 offen
L_qw:
  s_lshr_b32 s26, s20, 4
  s_and_b32 s27, s26, 7
  s_lshl_b32 s27, s27, 2
  s_add_u32 s27, s27, s3
  s_lshl_b32 s27, s27, 14
  s_lshr_b32 s26, s26, 3
  s_lshl_b32 s26, s26, 13
  s_add_u32 s26, s26, s27
  s_add_u32 s26, s26, 65536
  s_add_u32 s27, s26, 4096
  v_lshlrev_b32 v13, 4, v3
  v_bfe_u32 v14, v0, 4, 1
  v_lshl_or_b32 v13, v14, 3, v13
  v_lshrrev_b32 v14, 5, v0
  v_lshl_or_b32 v13, v14, 2, v13
  s_lshl_b32 s29, s3, 8
  v_add_u32 v13, s29, v13
  v_and_b32 v8, 1, v0
  v_bfe_u32 v9, v0, 1, 2
  v_lshlrev_b32 v8, 4, v8
  v_mov_b32 v10, 0xffff
  v_cmp_eq_u32 s[56:57], 0, v9
  v_cmp_eq_u32 s[58:59], 1, v9
  v_cmp_eq_u32 s[62:63], 2, v9
  v_cmp_eq_u32 vcc, 3, v9
  v_lshlrev_b32 v8, v8, v10
  v_cndmask_b32 v4, 0, v8, s[56:57]
  v_cndmask_b32 v5, 0, v8, s[58:59]
  v_cndmask_b32 v6, 0, v8, s[62:63]
  v_cndmask_b32 v7, 0, v8, vcc
  s_waitcnt lgkmcnt(0)
  s_mul_i32 s21, s21, 0x9E3779B1
  s_add_u32 s21, s21, 0x7F4A7C15
  s_cmp_eq_u32 s3, 0
  s_cbranch_scc1 L_qpoll
  v_mov_b32 v14, 13312
  s_nop 1
L_fw:
  ds_read_b32 v15, v14
  s_waitcnt lgkmcnt(0)
  v_readfirstlane_b32 s29, v15
  s_cmp_lg_u32 s29, 0
  s_nop 2
  s_cbranch_scc1 L_fok
  s_sleep 2
  s_sub_u32 s22, s22, 1
  s_cbranch_scc0 L_fw
  s_mov_b32 s22, 0
L_fok:
L_qpoll:
  s_mov_b64 s[32:33], -1
  s_mov_b64 s[34:35], -1
  s_mov_b64 s[36:37], -1
  s_mov_b64 s[38:39], -1
  s_mov_b64 s[40:41], -1
  s_mov_b64 s[42:43], -1
  s_mov_b64 s[44:45], -1
  s_mov_b64 s[46:47], -1
L_poll0:
  s_mov_b64 exec, s[32:33]
  buffer_load_dwordx4 v[128:131], v12, s[12:15], s26 offen offset:0 sc1
  s_mov_b64 exec, s[34:35]
  buffer_load_dwordx4 v[132:135], v12, s[12:15], s26 offen offset:1024 sc1
  s_mov_b64 exec, s[36:37]
  buffer_load_dwordx4 v[136:139], v12, s[12:15], s26 offen offset:2048 sc1
  s_mov_b64 exec, s[38:39]
  buffer_load_dwordx4 v[140:143], v12, s[12:15], s26 offen offset:3072 sc1
  s_mov_b64 exec, s[40:41]
  buffer_load_dwordx4 v[144:147], v12, s[12:15], s27 offen offset:0 sc1
  s_mov_b64 exec, s[42:43]
  buffer_load_dwordx4 v[148:151], v12, s[12:15], s27 offen offset:1024 sc1
  s_mov_b64 exec, s[44:45]
  buffer_load_dwordx4 v[152:155], v12, s[12:15], s27 offen offset:2048 sc1
  s_mov_b64 exec, s[46:47]
  buffer_load_dwordx4 v[156:159], v12, s[12:15], s27 offen offset:3072 sc1
  s_mov_b32 s58, 0
  s_waitcnt vmcnt(0)
  s_mov_b64 exec, s[32:33]
  v_cmpx_eq_u32 vcc, s21, v129
  v_cmpx_eq_u32 vcc, s21, v131
  s_andn2_b64 s[32:33], s[32:33], exec
  s_addc_u32 s58, s58, 0
  s_mov_b64 exec, s[34:35]
  v_cmpx_eq_u32 vcc, s21, v133
  v_cmpx_eq_u32 vcc, s21, v135
  s_andn2_b64 s[34:35], s[34:35], exec
  s_addc_u32 s58, s58, 0
  s_mov_b64 exec, s[36:37]
  v_cmpx_eq_u32 vcc, s21, v137
  v_cmpx_eq_u32 vcc, s21, v139
  s_andn2_b64 s[36:37], s[36:37], exec
  s_addc_u32 s58, s58, 0
  s_mov_b64 exec, s[38:39]
  v_cmpx_eq_u32 vcc, s21, v141
  v_cmpx_eq_u32 vcc, s21, v143
  s_andn2_b64 s[38:39], s[38:39], exec
  s_addc_u32 s58, s58, 0
  s_mov_b64 exec, s[40:41]
  v_cmpx_eq_u32 vcc, s21, v145
  v_cmpx_eq_u32 vcc, s21, v147
  s_andn2_b64 s[40:41], s[40:41], exec
  s_addc_u32 s58, s58, 0
  s_mov_b64 exec, s[42:43]
  v_cmpx_eq_u32 vcc, s21, v149
  v_cmpx_eq_u32 vcc, s21, v151
  s_andn2_b64 s[42:43], s[42:43], exec
  s_addc_u32 s58, s58, 0
  s_mov_b64 exec, s[44:45]
  v_cmpx_eq_u32 vcc, s21, v153
  v_cmpx_eq_u32 vcc, s21, v155
  s_andn2_b64 s[44:45], s[44:45], exec
  s_addc_u32 s58, s58, 0
  s_mov_b64 exec, s[46:47]
  v_cmpx_eq_u32 vcc, s21, v157
  v_cmpx_eq_u32 vcc, s21, v159
  s_andn2_b64 s[46:47], s[46:47], exec
  s_addc_u32 s58, s58, 0
  s_mov_b64 exec, -1
  s_cmp_eq_u32 s58, 0
  s_cbranch_scc1 L_pok0
  s_sub_u32 s22, s22, 1
  s_cbranch_scc0 L_poll0
  s_mov_b32 s22, 0
L_pok0:
  v_add_f32 v128, v128, v132
  v_add_f32 v130, v130, v134
  v_add_f32 v136, v136, v140
  v_add_f32 v138, v138, v142
  v_add_f32 v144, v144, v148
  v_add_f32 v146, v146, v150
  v_add_f32 v152, v152, v156
  v_add_f32 v154, v154, v158
  v_add_f32 v128, v128, v136
  v_add_f32 v130, v130, v138
  v_add_f32 v144, v144, v152
  v_add_f32 v146, v146, v154
  v_add_f32 v128, v128, v144
  v_add_f32 v130, v130, v146
  v_cvt_pk_bf16_f32 v128, v128, v130
  ds_write_b32 v13, v128 offset:0
  s_waitcnt lgkmcnt(0)
  s_barrier
  v_lshrrev_b32 v46, 1, v0
  v_mul_u32_u24 v46, 2048, v46
  v_and_b32 v14, 1, v0
  v_lshl_add_u32 v46, v14, 4, v46
  s_bfe_u32 s26, s2, 0x20001
  s_mul_i32 s31, s26, 131072
  s_lshr_b32 s27, s25, 4
  s_lshl_b32 s27, s27, 10
  s_add_u32 s31, s31, s27
  s_and_b32 s27, s2, 1
  s_lshl_b32 s27, s27, 9
  s_add_u32 s31, s31, s27
  s_and_b32 s27, s25, 15
  s_lshl_b32 s27, s27, 5
  s_add_u32 s31, s31, s27
  s_mov_b32 s62, 3
  s_mov_b32 s63, 3
  s_cmp_eq_u32 s3, 3
  s_cselect_b64 s[60:61], 0, -1
  s_cmp_eq_u32 s3, 99
  s_cbranch_scc1 L_gate
  s_cmp_eq_u32 s3, 0
  s_cbranch_scc1 L_tail
  s_cmp_eq_u32 s3, 3
  s_cbranch_scc1 L_tail
  s_cmp_ge_u32 s2, 224
  s_cbranch_scc1 L_tail
  s_cmp_eq_u32 s3, 1
  s_cbranch_scc1 L_tail
  s_branch L_mlp2
.p2align 6
L_tail:
  v_mul_u32_u24 v13, 524288, v1
  v_mul_u32_u24 v14, 4096, v2
  v_add_u32 v13, v13, v14
  v_and_b32 v14, 7, v0
  v_lshl_add_u32 v13, v14, 4, v13
  v_and_b32 v14, 3, v0
  v_lshlrev_b32 v14, 4, v14
  v_lshl_or_b32 v14, v2, 6, v14
  v_lshl_or_b32 v14, v1, 13, v14
  s_lshr_b32 s27, s28, 3
  s_mul_i32 s26, s27, 16384
  s_and_b32 s29, s28, 7
  s_lshl_b32 s29, s29, 7
  s_add_u32 s26, s26, s29
  s_add_u32 s26, s26, 1048576
  s_lshl_b32 s27, s27, 8
  s_add_u32 s27, s27, 2621440
  s_lshl_b32 s29, s3, 10
  s_add_u32 s29, s29, 8704
  v_add_u32 v15, s29, v12
  s_lshl_b32 s29, s30, 6
  s_add_u32 s29, s29, s23
  s_mul_i32 s29, s29, 2048
  s_add_u32 s29, s29, 3145728
  s_add_u32 s24, s31, 3145728
  s_add_u32 s25, s31, 3211264
  v_mov_b32 v53, s21
  v_mov_b32 v55, s21
  v_mov_b32 v57, s21
  v_mov_b32 v59, s21
  s_add_u32 s31, s31, 4194304
  v_cmp_gt_u32 s[56:57], 48, v0
  v_add_u32 v47, 65536, v46
  s_nop 0
  v_cndmask_b32 v47, v46, v47, s[56:57]
  s_cmp_eq_u32 s3, 0
  s_cselect_b64 s[50:51], -1, 0
  s_mov_b32 s48, 0x07060302
  s_mov_b32 s49, 0x05040100
L_tail2:
  s_mov_b64 exec, s[60:61]
  s_waitcnt vmcnt(0)
  s_cbranch_execz L_sk23
  s_barrier
L_sk23:
  s_mov_b64 s[32:33], s[60:61]
  s_mov_b64 s[34:35], s[60:61]
  s_mov_b64 s[36:37], s[60:61]
  s_mov_b64 s[38:39], s[60:61]
  s_mov_b64 s[40:41], s[50:51]
  s_mov_b64 s[42:43], s[50:51]
L_poll1:
  s_mov_b64 exec, s[32:33]
  buffer_load_dwordx4 v[64:67], v13, s[12:15], s26 offen offset:0 sc1
  s_mov_b64 exec, s[34:35]
  buffer_load_dwordx4 v[68:71], v13, s[12:15], s26 offen offset:1024 sc1
  s_mov_b64 exec, s[36:37]
  buffer_load_dwordx4 v[72:75], v13, s[12:15], s26 offen offset:2048 sc1
  s_mov_b64 exec, s[38:39]
  buffer_load_dwordx4 v[76:79], v13, s[12:15], s26 offen offset:3072 sc1
  s_mov_b64 exec, s[40:41]
  buffer_load_dwordx4 v[128:131], v46, s[12:15], s31 offen sc1
  s_mov_b64 exec, s[42:43]
  buffer_load_dwordx4 v[132:135], v47, s[12:15], s31 offen sc1
  s_mov_b32 s58, 0
  s_waitcnt vmcnt(0)
  s_mov_b64 exec, s[32:33]
  v_perm_b32 v92, v65, v67, s48
  v_cmpx_eq_u32 vcc, s21, v92
  s_andn2_b64 s[32:33], s[32:33], exec
  s_addc_u32 s58, s58, 0
  s_mov_b64 exec, s[34:35]
  v_perm_b32 v93, v69, v71, s48
  v_cmpx_eq_u32 vcc, s21, v93
  s_andn2_b64 s[34:35], s[34:35], exec
  s_addc_u32 s58, s58, 0
  s_mov_b64 exec, s[36:37]
  v_perm_b32 v94, v73, v75, s48
  v_cmpx_eq_u32 vcc, s21, v94
  s_andn2_b64 s[36:37], s[36:37], exec
  s_addc_u32 s58, s58, 0
  s_mov_b64 exec, s[38:39]
  v_perm_b32 v95, v77, v79, s48
  v_cmpx_eq_u32 vcc, s21, v95
  s_andn2_b64 s[38:39], s[38:39], exec
  s_addc_u32 s58, s58, 0
  s_mov_b64 exec, s[40:41]
  v_cmpx_eq_u32 vcc, s21, v129
  v_cmpx_eq_u32 vcc, s21, v131
  s_andn2_b64 s[40:41], s[40:41], exec
  s_addc_u32 s58, s58, 0
  s_mov_b64 exec, s[42:43]
  v_cmpx_eq_u32 vcc, s21, v133
  v_cmpx_eq_u32 vcc, s21, v135
  s_andn2_b64 s[42:43], s[42:43], exec
  s_addc_u32 s58, s58, 0
  s_mov_b64 exec, s[60:61]
  s_cmp_eq_u32 s58, 0
  s_cbranch_scc1 L_pok1
  s_sleep 1
  s_sub_u32 s22, s22, 1
  s_cbranch_scc0 L_poll1
  s_mov_b32 s22, 0
L_pok1:
  v_perm_b32 v80, v65, v67, s49
  v_perm_b32 v81, v69, v71, s49
  v_perm_b32 v82, v73, v75, s49
  v_perm_b32 v83, v77, v79, s49
  v_max3_f32 v84, v80, v81, v82
  v_max_f32 v84, v84, v83
  v_mov_b32 v85, v84
  s_nop 1
  v_permlane16_swap_b32 v84, v85
  v_max_f32 v84, v84, v85
  v_mov_b32 v85, v84
  s_nop 1
  v_permlane32_swap_b32 v84, v85
  v_max_f32 v84, v84, v85
  v_sub_f32 v92, v80, v84
  v_sub_f32 v93, v81, v84
  v_sub_f32 v94, v82, v84
  v_sub_f32 v95, v83, v84
  v_exp_f32 v92, v92
  v_exp_f32 v93, v93
  v_exp_f32 v94, v94
  v_exp_f32 v95, v95
  v_mul_f32_dpp v87, v92, v80 quad_perm:[0,0,2,2] row_mask:0xf bank_mask:0xf
  v_mul_f32_dpp v88, v92, v64 quad_perm:[0,0,2,2] row_mask:0xf bank_mask:0xf
  v_mul_f32_dpp v90, v92, v66 quad_perm:[0,0,2,2] row_mask:0xf bank_mask:0xf
  v_fmac_f32_dpp v87, v93, v81 quad_perm:[0,0,2,2] row_mask:0xf bank_mask:0xf
  v_fmac_f32_dpp v88, v93, v68 quad_perm:[0,0,2,2] row_mask:0xf bank_mask:0xf
  v_fmac_f32_dpp v90, v93, v70 quad_perm:[0,0,2,2] row_mask:0xf bank_mask:0xf
  v_fmac_f32_dpp v87, v94, v82 quad_perm:[0,0,2,2] row_mask:0xf bank_mask:0xf
  v_fmac_f32_dpp v88, v94, v72 quad_perm:[0,0,2,2] row_mask:0xf bank_mask:0xf
  v_fmac_f32_dpp v90, v94, v74 quad_perm:[0,0,2,2] row_mask:0xf bank_mask:0xf
  v_fmac_f32_dpp v87, v95, v83 quad_perm:[0,0,2,2] row_mask:0xf bank_mask:0xf
  v_fmac_f32_dpp v88, v95, v76 quad_perm:[0,0,2,2] row_mask:0xf bank_mask:0xf
  v_fmac_f32_dpp v90, v95, v78 quad_perm:[0,0,2,2] row_mask:0xf bank_mask:0xf
  v_mov_b32 v91, v87
  s_nop 1
  v_permlane32_swap_b32 v87, v91
  v_permlane32_swap_b32 v88, v90
  v_add_f32 v87, v87, v91
  v_add_f32 v88, v88, v90
  s_nop 1
  v_permlane16_swap_b32 v88, v87
  v_add_f32 v88, v88, v87
  v_mov_b32 v87, v88
  s_nop 1
  v_permlane16_swap_b32 v88, v87
  s_nop 1
  v_rcp_f32_dpp v87, v87 quad_perm:[1,1,3,3] row_mask:0xf bank_mask:0xf
  s_nop 0
  v_mul_f32 v88, v88, v87
  v_cvt_pk_bf16_f32 v88, v88, v88
  s_nop 1
  v_mov_b32_dpp v88, v88 row_shr:4 row_mask:0x5 bank_mask:0xa
  s_nop 1
  v_mov_b32_dpp v88, v88 row_shl:4 row_mask:0xa bank_mask:0x5
  s_nop 1
  v_and_b32_dpp v96, v88, v4 quad_perm:[0,0,0,0] row_mask:0xf bank_mask:0xf
  v_and_b32_dpp v97, v88, v5 quad_perm:[0,0,0,0] row_mask:0xf bank_mask:0xf
  v_and_b32_dpp v98, v88, v6 quad_perm:[0,0,0,0] row_mask:0xf bank_mask:0xf
  v_and_b32_dpp v99, v88, v7 quad_perm:[0,0,0,0] row_mask:0xf bank_mask:0xf
  v_and_b32_dpp v100, v88, v4 quad_perm:[1,1,1,1] row_mask:0xf bank_mask:0xf
  v_and_b32_dpp v101, v88, v5 quad_perm:[1,1,1,1] row_mask:0xf bank_mask:0xf
  v_and_b32_dpp v102, v88, v6 quad_perm:[1,1,1,1] row_mask:0xf bank_mask:0xf
  v_and_b32_dpp v103, v88, v7 quad_perm:[1,1,1,1] row_mask:0xf bank_mask:0xf
  v_and_b32_dpp v104, v88, v4 quad_perm:[2,2,2,2] row_mask:0xf bank_mask:0xf
  v_and_b32_dpp v105, v88, v5 quad_perm:[2,2,2,2] row_mask:0xf bank_mask:0xf
  v_and_b32_dpp v106, v88, v6 quad_perm:[2,2,2,2] row_mask:0xf bank_mask:0xf
  v_and_b32_dpp v107, v88, v7 quad_perm:[2,2,2,2] row_mask:0xf bank_mask:0xf
  v_and_b32_dpp v108, v88, v4 quad_perm:[3,3,3,3] row_mask:0xf bank_mask:0xf
  v_and_b32_dpp v109, v88, v5 quad_perm:[3,3,3,3] row_mask:0xf bank_mask:0xf
  v_and_b32_dpp v110, v88, v6 quad_perm:[3,3,3,3] row_mask:0xf bank_mask:0xf
  v_and_b32_dpp v111, v88, v7 quad_perm:[3,3,3,3] row_mask:0xf bank_mask:0xf
  v_mfma_f32_16x16x32_bf16 v[48:51], v[96:99], v[16:19], 0
  v_mfma_f32_16x16x32_bf16 v[48:51], v[100:103], v[20:23], v[48:51]
  v_mfma_f32_16x16x32_bf16 v[48:51], v[104:107], v[24:27], v[48:51]
  v_mfma_f32_16x16x32_bf16 v[48:51], v[108:111], v[28:31], v[48:51]
  s_cbranch_execz L_fin
  s_cmp_eq_u32 s3, 0
  s_cbranch_scc1 L_fin
  s_nop 4
  ds_write_b128 v15, v[48:51]
  s_waitcnt lgkmcnt(0)
  s_barrier
  s_endpgm
L_fin:
  s_cbranch_execz L_sk24
  s_barrier
L_sk24:
  ds_read_b128 v[112:115], v12 offset:9728
  ds_read_b128 v[116:119], v12 offset:10752
  ds_read_b128 v[120:123], v12 offset:11776
  s_waitcnt lgkmcnt(1)
  v_add_f32 v48, v48, v112
  v_add_f32 v49, v49, v113
  v_add_f32 v50, v50, v114
  v_add_f32 v51, v51, v115
  v_add_f32 v48, v48, v116
  v_add_f32 v49, v49, v117
  v_add_f32 v50, v50, v118
  v_add_f32 v51, v51, v119
  s_waitcnt lgkmcnt(0)
  v_add_f32 v52, v48, v120
  v_add_f32 v54, v49, v121
  v_add_f32 v56, v50, v122
  v_add_f32 v58, v51, v123
  buffer_store_dwordx4 v[52:55], v12, s[12:15], s29 offen sc1
  buffer_store_dwordx4 v[56:59], v12, s[12:15], s29 offen offset:1024 sc1
  v_cndmask_b32 v136, 0, v132, s[56:57]
  v_cndmask_b32 v138, 0, v134, s[56:57]
  v_add_f32 v136, v128, v136
  v_add_f32 v138, v130, v138
  s_nop 1
  v_permlane32_swap_b32 v136, v138
  v_add_f32 v136, v136, v138
  v_mov_b32 v138, v136
  s_nop 1
  v_permlane16_swap_b32 v136, v138
  v_add_f32 v136, v136, v138
  s_nop 1
  v_add_f32_dpp v136, v136, v136 row_ror:8 row_mask:0xf bank_mask:0xf
  s_nop 1
  v_add_f32_dpp v136, v136, v136 row_ror:4 row_mask:0xf bank_mask:0xf
  s_nop 1
  v_add_f32_dpp v136, v136, v136 quad_perm:[2,3,0,1] row_mask:0xf bank_mask:0xf
  v_cvt_pk_bf16_f32 v136, v136, v136
  v_and_b32 v136, 0xffff0000, v136
  v_lshlrev_b32 v63, 16, v63
  v_lshlrev_b32 v62, 16, v62
  v_add_f32 v136, v136, v63
  v_cvt_pk_bf16_f32 v136, v136, v136
  v_and_b32 v136, 0xffff0000, v136
  v_mul_f32 v63, 0xbfb8aa3b, v136
  v_exp_f32 v63, v63
  s_nop 0
  v_add_f32 v63, 1.0, v63
  v_rcp_f32 v63, v63
  s_nop 0
  v_mul_f32 v63, v63, v136
  v_cvt_pk_bf16_f32 v63, v63, v63
  v_and_b32 v63, 0xffff0000, v63
  s_mov_b64 s[32:33], s[60:61]
  s_mov_b64 s[34:35], s[60:61]
L_poll2:
  s_mov_b64 exec, s[32:33]
  buffer_load_dwordx4 v[140:143], v46, s[12:15], s24 offen sc1
  s_mov_b64 exec, s[34:35]
  buffer_load_dwordx4 v[144:147], v46, s[12:15], s25 offen sc1
  s_mov_b32 s58, 0
  s_waitcnt vmcnt(0)
  s_mov_b64 exec, s[32:33]
  v_cmpx_eq_u32 vcc, s21, v141
  v_cmpx_eq_u32 vcc, s21, v143
  s_andn2_b64 s[32:33], s[32:33], exec
  s_addc_u32 s58, s58, 0
  s_mov_b64 exec, s[34:35]
  v_cmpx_eq_u32 vcc, s21, v145
  v_cmpx_eq_u32 vcc, s21, v147
  s_andn2_b64 s[34:35], s[34:35], exec
  s_addc_u32 s58, s58, 0
  s_mov_b64 exec, s[60:61]
  s_cmp_eq_u32 s58, 0
  s_cbranch_scc1 L_pok2
  s_sleep 1
  s_sub_u32 s22, s22, 1
  s_cbranch_scc0 L_poll2
  s_mov_b32 s22, 0
L_pok2:
  v_add_f32 v148, v140, v144
  v_add_f32 v150, v142, v146
  s_nop 1
  v_permlane32_swap_b32 v148, v150
  v_add_f32 v148, v148, v150
  v_mov_b32 v150, v148
  s_nop 1
  v_permlane16_swap_b32 v148, v150
  v_add_f32 v148, v148, v150
  s_nop 1
  v_add_f32_dpp v148, v148, v148 row_ror:8 row_mask:0xf bank_mask:0xf
  s_nop 1
  v_add_f32_dpp v148, v148, v148 row_ror:4 row_mask:0xf bank_mask:0xf
  s_nop 1
  v_add_f32_dpp v148, v148, v148 quad_perm:[2,3,0,1] row_mask:0xf bank_mask:0xf
  v_cvt_pk_bf16_f32 v148, v148, v148
  v_and_b32 v148, 0xffff0000, v148
  v_mul_f32 v148, v148, v63
  v_cvt_pk_bf16_f32 v148, v148, v148
  v_and_b32 v148, 0xffff0000, v148
  v_add_f32 v148, v148, v62
  v_cvt_pk_bf16_f32 v148, v148, v148
  s_and_b64 exec, exec, s[62:63]
  buffer_store_short v148, v61, s[52:55], 0 offen
  s_cbranch_execz L_dry2
  s_cmp_lg_u32 s2, 0
  s_cbranch_scc1 L_end2
  s_mov_b64 exec, 1
  buffer_store_dword v53, off, s[12:15], 0 sc1
L_end2:
  s_endpgm
L_dry2:
  s_mov_b64 s[60:61], -1
  s_branch L_tail2
.p2align 6
L_gate:
  s_add_u32 s26, s31, 4194304
  v_cmp_gt_u32 s[56:57], 48, v0
  v_add_u32 v47, 65536, v46
  s_nop 0
  v_cndmask_b32 v47, v46, v47, s[56:57]
  s_mov_b64 s[32:33], -1
  s_mov_b64 s[34:35], -1
L_poll3:
  s_mov_b64 exec, s[32:33]
  buffer_load_dwordx4 v[128:131], v46, s[12:15], s26 offen sc1
  s_mov_b64 exec, s[34:35]
  buffer_load_dwordx4 v[132:135], v47, s[12:15], s26 offen sc1
  s_mov_b32 s58, 0
  s_waitcnt vmcnt(0)
  s_mov_b64 exec, s[32:33]
  v_cmpx_eq_u32 vcc, s21, v129
  v_cmpx_eq_u32 vcc, s21, v131
  s_andn2_b64 s[32:33], s[32:33], exec
  s_addc_u32 s58, s58, 0
  s_mov_b64 exec, s[34:35]
  v_cmpx_eq_u32 vcc, s21, v133
  v_cmpx_eq_u32 vcc, s21, v135
  s_andn2_b64 s[34:35], s[34:35], exec
  s_addc_u32 s58, s58, 0
  s_mov_b64 exec, -1
  s_cmp_eq_u32 s58, 0
  s_cbranch_scc1 L_pok3
  s_sleep 64
  s_sub_u32 s22, s22, 1
  s_cbranch_scc0 L_poll3
  s_mov_b32 s22, 0
L_pok3:
  v_cndmask_b32 v136, 0, v132, s[56:57]
  v_cndmask_b32 v138, 0, v134, s[56:57]
  v_add_f32 v136, v128, v136
  v_add_f32 v138, v130, v138
  s_nop 1
  v_permlane32_swap_b32 v136, v138
  v_add_f32 v136, v136, v138
  v_mov_b32 v138, v136
  s_nop 1
  v_permlane16_swap_b32 v136, v138
  v_add_f32 v136, v136, v138
  s_nop 1
  v_add_f32_dpp v136, v136, v136 row_ror:8 row_mask:0xf bank_mask:0xf
  s_nop 1
  v_add_f32_dpp v136, v136, v136 row_ror:4 row_mask:0xf bank_mask:0xf
  s_nop 1
  v_add_f32_dpp v136, v136, v136 quad_perm:[2,3,0,1] row_mask:0xf bank_mask:0xf
  v_cvt_pk_bf16_f32 v136, v136, v136
  v_and_b32 v136, 0xffff0000, v136
  v_lshlrev_b32 v63, 16, v63
  v_lshlrev_b32 v62, 16, v62
  v_add_f32 v136, v136, v63
  v_cvt_pk_bf16_f32 v136, v136, v136
  v_and_b32 v136, 0xffff0000, v136
  v_mul_f32 v63, 0xbfb8aa3b, v136
  v_exp_f32 v63, v63
  s_nop 0
  v_add_f32 v63, 1.0, v63
  v_rcp_f32 v63, v63
  s_nop 0
  v_mul_f32 v63, v63, v136
  v_cvt_pk_bf16_f32 v63, v63, v63
  v_and_b32 v63, 0xffff0000, v63
  s_nop 0
  s_branch L_tail
.p2align 6
L_h1b:
  s_load_dword s31, s[12:13], 0
  v_and_b32 v8, 1, v0
  v_bfe_u32 v9, v0, 1, 2
  v_lshlrev_b32 v8, 4, v8
  v_mov_b32 v10, 0xffff
  v_cmp_eq_u32 s[56:57], 0, v9
  v_cmp_eq_u32 s[58:59], 1, v9
  v_cmp_eq_u32 s[62:63], 2, v9
  v_cmp_eq_u32 vcc, 3, v9
  v_lshlrev_b32 v8, v8, v10
  v_cndmask_b32 v4, 0, v8, s[56:57]
  v_cndmask_b32 v5, 0, v8, s[58:59]
  v_cndmask_b32 v6, 0, v8, s[62:63]
  v_cndmask_b32 v7, 0, v8, vcc
  v_or_b32 v116, v4, v6
  v_or_b32 v117, v5, v7
  v_mov_b32 v120, 0
  v_mov_b32 v121, 0
  v_mov_b32 v124, 0
  v_mov_b32 v125, 0
  v_mov_b32 v128, 0
  v_mov_b32 v129, 0
  v_mov_b32 v132, 0
  v_mov_b32 v133, 0
  v_mov_b32 v136, 0
  v_mov_b32 v137, 0
  v_mov_b32 v140, 0
  v_mov_b32 v141, 0
  v_mov_b32 v144, 0
  v_mov_b32 v145, 0
  v_mov_b32 v148, 0
  v_mov_b32 v149, 0
  v_mov_b32 v152, 0
  v_mov_b32 v153, 0
  v_lshlrev_b32 v13, 4, v13
  v_lshl_or_b32 v13, v2, 7, v13
  s_lshl_b32 s26, s2, 10
  s_add_u32 s26, s26, 655360
  s_waitcnt lgkmcnt(0)
  s_mul_i32 s31, s31, 0x9E3779B1
  s_add_u32 s31, s31, 0x7F4A7C15
  v_mov_b32 v161, s31
  v_mov_b32 v163, s31
  v_mov_b32 v165, s31
  v_mov_b32 v167, s31
  s_waitcnt vmcnt(9)
  v_lshlrev_b32 v96, 16, v32
  v_and_b32 v97, 0xffff0000, v32
  v_lshlrev_b32 v98, 16, v33
  v_and_b32 v99, 0xffff0000, v33
  v_lshlrev_b32 v100, 16, v34
  v_and_b32 v101, 0xffff0000, v34
  v_lshlrev_b32 v102, 16, v35
  v_and_b32 v103, 0xffff0000, v35
  v_lshlrev_b32 v104, 16, v36
  v_and_b32 v105, 0xffff0000, v36
  v_lshlrev_b32 v106, 16, v37
  v_and_b32 v107, 0xffff0000, v37
  v_lshlrev_b32 v108, 16, v38
  v_and_b32 v109, 0xffff0000, v38
  v_lshlrev_b32 v110, 16, v39
  v_and_b32 v111, 0xffff0000, v39
  v_pk_add_f32 v[48:49], v[96:97], v[98:99]
  v_pk_add_f32 v[50:51], v[100:101], v[102:103]
  v_pk_add_f32 v[48:49], v[48:49], v[104:105]
  v_pk_add_f32 v[50:51], v[50:51], v[106:107]
  v_pk_add_f32 v[48:49], v[48:49], v[108:109]
  v_pk_add_f32 v[50:51], v[50:51], v[110:111]
  v_pk_add_f32 v[48:49], v[48:49], v[50:51]
  v_add_f32 v48, v48, v49
  s_nop 1
  v_add_f32_dpp v48, v48, v48 quad_perm:[1,0,3,2] row_mask:0xf bank_mask:0xf
  s_nop 1
  v_add_f32_dpp v48, v48, v48 quad_perm:[2,3,0,1] row_mask:0xf bank_mask:0xf
  s_nop 1
  v_add_f32_dpp v48, v48, v48 row_half_mirror row_mask:0xf bank_mask:0xf
  v_mov_b32 v49, v48
  s_nop 1
  v_permlane16_swap_b32 v48, v49
  v_add_f32 v48, v48, v49
  v_mov_b32 v49, v48
  s_nop 1
  v_permlane32_swap_b32 v48, v49
  v_add_f32 v48, v48, v49
  v_mul_f32 v48, 0x3b000000, v48
  v_pk_add_f32 v[96:97], v[96:97], v[48:49] op_sel_hi:[1,0] neg_lo:[0,1] neg_hi:[0,1]
  v_pk_add_f32 v[98:99], v[98:99], v[48:49] op_sel_hi:[1,0] neg_lo:[0,1] neg_hi:[0,1]
  v_pk_add_f32 v[100:101], v[100:101], v[48:49] op_sel_hi:[1,0] neg_lo:[0,1] neg_hi:[0,1]
  v_pk_add_f32 v[102:103], v[102:103], v[48:49] op_sel_hi:[1,0] neg_lo:[0,1] neg_hi:[0,1]
  v_pk_add_f32 v[104:105], v[104:105], v[48:49] op_sel_hi:[1,0] neg_lo:[0,1] neg_hi:[0,1]
  v_pk_add_f32 v[106:107], v[106:107], v[48:49] op_sel_hi:[1,0] neg_lo:[0,1] neg_hi:[0,1]
  v_pk_add_f32 v[108:109], v[108:109], v[48:49] op_sel_hi:[1,0] neg_lo:[0,1] neg_hi:[0,1]
  v_pk_add_f32 v[110:111], v[110:111], v[48:49] op_sel_hi:[1,0] neg_lo:[0,1] neg_hi:[0,1]
  v_pk_mul_f32 v[50:51], v[96:97], v[96:97]
  v_pk_mul_f32 v[52:53], v[98:99], v[98:99]
  v_pk_fma_f32 v[50:51], v[100:101], v[100:101], v[50:51]
  v_pk_fma_f32 v[52:53], v[102:103], v[102:103], v[52:53]
  v_pk_fma_f32 v[50:51], v[104:105], v[104:105], v[50:51]
  v_pk_fma_f32 v[52:53], v[106:107], v[106:107], v[52:53]
  v_pk_fma_f32 v[50:51], v[108:109], v[108:109], v[50:51]
  v_pk_fma_f32 v[52:53], v[110:111], v[110:111], v[52:53]
  v_pk_add_f32 v[50:51], v[50:51], v[52:53]
  v_add_f32 v50, v50, v51
  s_nop 1
  v_add_f32_dpp v50, v50, v50 quad_perm:[1,0,3,2] row_mask:0xf bank_mask:0xf
  s_nop 1
  v_add_f32_dpp v50, v50, v50 quad_perm:[2,3,0,1] row_mask:0xf bank_mask:0xf
  s_nop 1
  v_add_f32_dpp v50, v50, v50 row_half_mirror row_mask:0xf bank_mask:0xf
  v_mov_b32 v51, v50
  s_nop 1
  v_permlane16_swap_b32 v50, v51
  v_add_f32 v50, v50, v51
  v_mov_b32 v51, v50
  s_nop 1
  v_permlane32_swap_b32 v50, v51
  v_add_f32 v50, v50, v51
  v_mul_f32 v50, 0x3b000000, v50
  v_cvt_pk_bf16_f32 v49, v48, v50
  v_lshlrev_b32 v48, 16, v49
  v_and_b32 v50, 0xffff0000, v49
  v_add_f32 v50, 0x3727c5ac, v50
  v_cvt_pk_bf16_f32 v50, v50, v50
  v_and_b32 v50, 0xffff0000, v50
  v_sqrt_f32 v50, v50
  s_nop 0
  v_cvt_pk_bf16_f32 v50, v50, v50
  v_and_b32 v50, 0xffff0000, v50
  v_rcp_f32 v50, v50
  v_lshlrev_b32 v96, 16, v32
  v_and_b32 v97, 0xffff0000, v32
  v_lshlrev_b32 v98, 16, v33
  v_and_b32 v99, 0xffff0000, v33
  v_lshlrev_b32 v100, 16, v34
  v_and_b32 v101, 0xffff0000, v34
  v_lshlrev_b32 v102, 16, v35
  v_and_b32 v103, 0xffff0000, v35
  v_lshlrev_b32 v104, 16, v36
  v_and_b32 v105, 0xffff0000, v36
  v_lshlrev_b32 v106, 16, v37
  v_and_b32 v107, 0xffff0000, v37
  v_lshlrev_b32 v108, 16, v38
  v_and_b32 v109, 0xffff0000, v38
  v_lshlrev_b32 v110, 16, v39
  v_and_b32 v111, 0xffff0000, v39
  v_pk_add_f32 v[96:97], v[96:97], v[48:49] op_sel_hi:[1,0] neg_lo:[0,1] neg_hi:[0,1]
  v_pk_add_f32 v[98:99], v[98:99], v[48:49] op_sel_hi:[1,0] neg_lo:[0,1] neg_hi:[0,1]
  v_pk_add_f32 v[100:101], v[100:101], v[48:49] op_sel_hi:[1,0] neg_lo:[0,1] neg_hi:[0,1]
  v_pk_add_f32 v[102:103], v[102:103], v[48:49] op_sel_hi:[1,0] neg_lo:[0,1] neg_hi:[0,1]
  v_pk_add_f32 v[104:105], v[104:105], v[48:49] op_sel_hi:[1,0] neg_lo:[0,1] neg_hi:[0,1]
  v_pk_add_f32 v[106:107], v[106:107], v[48:49] op_sel_hi:[1,0] neg_lo:[0,1] neg_hi:[0,1]
  v_pk_add_f32 v[108:109], v[108:109], v[48:49] op_sel_hi:[1,0] neg_lo:[0,1] neg_hi:[0,1]
  v_pk_add_f32 v[110:111], v[110:111], v[48:49] op_sel_hi:[1,0] neg_lo:[0,1] neg_hi:[0,1]
  v_cvt_pk_bf16_f32 v32, v96, v97
  v_cvt_pk_bf16_f32 v33, v98, v99
  v_cvt_pk_bf16_f32 v34, v100, v101
  v_cvt_pk_bf16_f32 v35, v102, v103
  v_cvt_pk_bf16_f32 v36, v104, v105
  v_cvt_pk_bf16_f32 v37, v106, v107
  v_cvt_pk_bf16_f32 v38, v108, v109
  v_cvt_pk_bf16_f32 v39, v110, v111
  v_lshlrev_b32 v96, 16, v32
  v_and_b32 v97, 0xffff0000, v32
  v_lshlrev_b32 v98, 16, v33
  v_and_b32 v99, 0xffff0000, v33
  v_lshlrev_b32 v100, 16, v34
  v_and_b32 v101, 0xffff0000, v34
  v_lshlrev_b32 v102, 16, v35
  v_and_b32 v103, 0xffff0000, v35
  v_lshlrev_b32 v104, 16, v36
  v_and_b32 v105, 0xffff0000, v36
  v_lshlrev_b32 v106, 16, v37
  v_and_b32 v107, 0xffff0000, v37
  v_lshlrev_b32 v108, 16, v38
  v_and_b32 v109, 0xffff0000, v38
  v_lshlrev_b32 v110, 16, v39
  v_and_b32 v111, 0xffff0000, v39
  v_pk_mul_f32 v[96:97], v[96:97], v[50:51] op_sel_hi:[1,0]
  v_pk_mul_f32 v[98:99], v[98:99], v[50:51] op_sel_hi:[1,0]
  v_pk_mul_f32 v[100:101], v[100:101], v[50:51] op_sel_hi:[1,0]
  v_pk_mul_f32 v[102:103], v[102:103], v[50:51] op_sel_hi:[1,0]
  v_pk_mul_f32 v[104:105], v[104:105], v[50:51] op_sel_hi:[1,0]
  v_pk_mul_f32 v[106:107], v[106:107], v[50:51] op_sel_hi:[1,0]
  v_pk_mul_f32 v[108:109], v[108:109], v[50:51] op_sel_hi:[1,0]
  v_pk_mul_f32 v[110:111], v[110:111], v[50:51] op_sel_hi:[1,0]
  v_cvt_pk_bf16_f32 v32, v96, v97
  v_cvt_pk_bf16_f32 v33, v98, v99
  v_cvt_pk_bf16_f32 v34, v100, v101
  v_cvt_pk_bf16_f32 v35, v102, v103
  v_cvt_pk_bf16_f32 v36, v104, v105
  v_cvt_pk_bf16_f32 v37, v106, v107
  v_cvt_pk_bf16_f32 v38, v108, v109
  v_cvt_pk_bf16_f32 v39, v110, v111
  v_lshlrev_b32 v96, 16, v32
  v_and_b32 v97, 0xffff0000, v32
  v_lshlrev_b32 v98, 16, v33
  v_and_b32 v99, 0xffff0000, v33
  v_lshlrev_b32 v100, 16, v34
  v_and_b32 v101, 0xffff0000, v34
  v_lshlrev_b32 v102, 16, v35
  v_and_b32 v103, 0xffff0000, v35
  v_lshlrev_b32 v104, 16, v36
  v_and_b32 v105, 0xffff0000, v36
  v_lshlrev_b32 v106, 16, v37
  v_and_b32 v107, 0xffff0000, v37
  v_lshlrev_b32 v108, 16, v38
  v_and_b32 v109, 0xffff0000, v38
  v_lshlrev_b32 v110, 16, v39
  v_and_b32 v111, 0xffff0000, v39
  v_pk_add_f32 v[54:55], v[96:97], v[98:99]
  v_pk_add_f32 v[56:57], v[100:101], v[102:103]
  v_pk_add_f32 v[54:55], v[54:55], v[104:105]
  v_pk_add_f32 v[56:57], v[56:57], v[106:107]
  v_pk_add_f32 v[54:55], v[54:55], v[108:109]
  v_pk_add_f32 v[56:57], v[56:57], v[110:111]
  v_pk_add_f32 v[54:55], v[54:55], v[56:57]
  v_add_f32 v54, v54, v55
  s_nop 1
  v_add_f32_dpp v54, v54, v54 quad_perm:[1,0,3,2] row_mask:0xf bank_mask:0xf
  s_nop 1
  v_add_f32_dpp v54, v54, v54 quad_perm:[2,3,0,1] row_mask:0xf bank_mask:0xf
  s_nop 1
  v_add_f32_dpp v54, v54, v54 row_half_mirror row_mask:0xf bank_mask:0xf
  v_mov_b32 v55, v54
  s_nop 1
  v_permlane16_swap_b32 v54, v55
  v_add_f32 v54, v54, v55
  v_mov_b32 v55, v54
  s_nop 1
  v_permlane32_swap_b32 v54, v55
  v_add_f32 v54, v54, v55
  v_mul_f32 v54, 0x3b000000, v54
  v_pk_add_f32 v[96:97], v[96:97], v[54:55] op_sel_hi:[1,0] neg_lo:[0,1] neg_hi:[0,1]
  v_pk_add_f32 v[98:99], v[98:99], v[54:55] op_sel_hi:[1,0] neg_lo:[0,1] neg_hi:[0,1]
  v_pk_add_f32 v[100:101], v[100:101], v[54:55] op_sel_hi:[1,0] neg_lo:[0,1] neg_hi:[0,1]
  v_pk_add_f32 v[102:103], v[102:103], v[54:55] op_sel_hi:[1,0] neg_lo:[0,1] neg_hi:[0,1]
  v_pk_add_f32 v[104:105], v[104:105], v[54:55] op_sel_hi:[1,0] neg_lo:[0,1] neg_hi:[0,1]
  v_pk_add_f32 v[106:107], v[106:107], v[54:55] op_sel_hi:[1,0] neg_lo:[0,1] neg_hi:[0,1]
  v_pk_add_f32 v[108:109], v[108:109], v[54:55] op_sel_hi:[1,0] neg_lo:[0,1] neg_hi:[0,1]
  v_pk_add_f32 v[110:111], v[110:111], v[54:55] op_sel_hi:[1,0] neg_lo:[0,1] neg_hi:[0,1]
  v_pk_mul_f32 v[56:57], v[96:97], v[96:97]
  v_pk_mul_f32 v[58:59], v[98:99], v[98:99]
  v_pk_fma_f32 v[56:57], v[100:101], v[100:101], v[56:57]
  v_pk_fma_f32 v[58:59], v[102:103], v[102:103], v[58:59]
  v_pk_fma_f32 v[56:57], v[104:105], v[104:105], v[56:57]
  v_pk_fma_f32 v[58:59], v[106:107], v[106:107], v[58:59]
  v_pk_fma_f32 v[56:57], v[108:109], v[108:109], v[56:57]
  v_pk_fma_f32 v[58:59], v[110:111], v[110:111], v[58:59]
  v_pk_add_f32 v[56:57], v[56:57], v[58:59]
  v_add_f32 v56, v56, v57
  s_nop 1
  v_add_f32_dpp v56, v56, v56 quad_perm:[1,0,3,2] row_mask:0xf bank_mask:0xf
  s_nop 1
  v_add_f32_dpp v56, v56, v56 quad_perm:[2,3,0,1] row_mask:0xf bank_mask:0xf
  s_nop 1
  v_add_f32_dpp v56, v56, v56 row_half_mirror row_mask:0xf bank_mask:0xf
  v_mov_b32 v57, v56
  s_nop 1
  v_permlane16_swap_b32 v56, v57
  v_add_f32 v56, v56, v57
  v_mov_b32 v57, v56
  s_nop 1
  v_permlane32_swap_b32 v56, v57
  v_add_f32 v56, v56, v57
  v_mul_f32 v56, 0x3b000000, v56
  v_cvt_pk_bf16_f32 v55, v54, v56
  v_lshlrev_b32 v54, 16, v55
  v_and_b32 v56, 0xffff0000, v55
  v_add_f32 v56, 0x3727c5ac, v56
  v_cvt_pk_bf16_f32 v56, v56, v56
  v_and_b32 v56, 0xffff0000, v56
  v_sqrt_f32 v56, v56
  s_nop 0
  v_cvt_pk_bf16_f32 v56, v56, v56
  v_and_b32 v56, 0xffff0000, v56
  v_rcp_f32 v56, v56
  s_waitcnt vmcnt(8)
  v_lshlrev_b32 v96, 16, v40
  v_and_b32 v97, 0xffff0000, v40
  v_lshlrev_b32 v98, 16, v41
  v_and_b32 v99, 0xffff0000, v41
  v_lshlrev_b32 v100, 16, v42
  v_and_b32 v101, 0xffff0000, v42
  v_lshlrev_b32 v102, 16, v43
  v_and_b32 v103, 0xffff0000, v43
  v_pk_add_f32 v[96:97], v[96:97], v[48:49] op_sel_hi:[1,0] neg_lo:[0,1] neg_hi:[0,1]
  v_pk_add_f32 v[98:99], v[98:99], v[48:49] op_sel_hi:[1,0] neg_lo:[0,1] neg_hi:[0,1]
  v_pk_add_f32 v[100:101], v[100:101], v[48:49] op_sel_hi:[1,0] neg_lo:[0,1] neg_hi:[0,1]
  v_pk_add_f32 v[102:103], v[102:103], v[48:49] op_sel_hi:[1,0] neg_lo:[0,1] neg_hi:[0,1]
  v_cvt_pk_bf16_f32 v40, v96, v97
  v_cvt_pk_bf16_f32 v41, v98, v99
  v_cvt_pk_bf16_f32 v42, v100, v101
  v_cvt_pk_bf16_f32 v43, v102, v103
  v_lshlrev_b32 v96, 16, v40
  v_and_b32 v97, 0xffff0000, v40
  v_lshlrev_b32 v98, 16, v41
  v_and_b32 v99, 0xffff0000, v41
  v_lshlrev_b32 v100, 16, v42
  v_and_b32 v101, 0xffff0000, v42
  v_lshlrev_b32 v102, 16, v43
  v_and_b32 v103, 0xffff0000, v43
  v_pk_mul_f32 v[96:97], v[96:97], v[50:51] op_sel_hi:[1,0]
  v_pk_mul_f32 v[98:99], v[98:99], v[50:51] op_sel_hi:[1,0]
  v_pk_mul_f32 v[100:101], v[100:101], v[50:51] op_sel_hi:[1,0]
  v_pk_mul_f32 v[102:103], v[102:103], v[50:51] op_sel_hi:[1,0]
  v_cvt_pk_bf16_f32 v40, v96, v97
  v_cvt_pk_bf16_f32 v41, v98, v99
  v_cvt_pk_bf16_f32 v42, v100, v101
  v_cvt_pk_bf16_f32 v43, v102, v103
  v_lshlrev_b32 v96, 16, v40
  v_and_b32 v97, 0xffff0000, v40
  v_lshlrev_b32 v98, 16, v41
  v_and_b32 v99, 0xffff0000, v41
  v_lshlrev_b32 v100, 16, v42
  v_and_b32 v101, 0xffff0000, v42
  v_lshlrev_b32 v102, 16, v43
  v_and_b32 v103, 0xffff0000, v43
  v_pk_add_f32 v[96:97], v[96:97], v[54:55] op_sel_hi:[1,0] neg_lo:[0,1] neg_hi:[0,1]
  v_pk_add_f32 v[98:99], v[98:99], v[54:55] op_sel_hi:[1,0] neg_lo:[0,1] neg_hi:[0,1]
  v_pk_add_f32 v[100:101], v[100:101], v[54:55] op_sel_hi:[1,0] neg_lo:[0,1] neg_hi:[0,1]
  v_pk_add_f32 v[102:103], v[102:103], v[54:55] op_sel_hi:[1,0] neg_lo:[0,1] neg_hi:[0,1]
  v_cvt_pk_bf16_f32 v40, v96, v97
  v_cvt_pk_bf16_f32 v41, v98, v99
  v_cvt_pk_bf16_f32 v42, v100, v101
  v_cvt_pk_bf16_f32 v43, v102, v103
  v_lshlrev_b32 v96, 16, v40
  v_and_b32 v97, 0xffff0000, v40
  v_lshlrev_b32 v98, 16, v41
  v_and_b32 v99, 0xffff0000, v41
  v_lshlrev_b32 v100, 16, v42
  v_and_b32 v101, 0xffff0000, v42
  v_lshlrev_b32 v102, 16, v43
  v_and_b32 v103, 0xffff0000, v43
  v_pk_mul_f32 v[96:97], v[96:97], v[56:57] op_sel_hi:[1,0]
  v_pk_mul_f32 v[98:99], v[98:99], v[56:57] op_sel_hi:[1,0]
  v_pk_mul_f32 v[100:101], v[100:101], v[56:57] op_sel_hi:[1,0]
  v_pk_mul_f32 v[102:103], v[102:103], v[56:57] op_sel_hi:[1,0]
  v_cvt_pk_bf16_f32 v104, v96, v96
  v_cvt_pk_bf16_f32 v105, v97, v97
  v_cvt_pk_bf16_f32 v106, v98, v98
  v_cvt_pk_bf16_f32 v107, v99, v99
  v_cvt_pk_bf16_f32 v108, v100, v100
  v_cvt_pk_bf16_f32 v109, v101, v101
  v_cvt_pk_bf16_f32 v110, v102, v102
  v_cvt_pk_bf16_f32 v111, v103, v103
  v_and_b32 v122, v104, v116
  v_and_b32 v123, v104, v117
  v_and_b32 v126, v105, v116
  v_and_b32 v127, v105, v117
  v_and_b32 v130, v106, v116
  v_and_b32 v131, v106, v117
  v_and_b32 v134, v107, v116
  v_and_b32 v135, v107, v117
  v_and_b32 v138, v108, v116
  v_and_b32 v139, v108, v117
  v_and_b32 v142, v109, v116
  v_and_b32 v143, v109, v117
  v_and_b32 v146, v110, v116
  v_and_b32 v147, v110, v117
  v_and_b32 v150, v111, v116
  v_and_b32 v151, v111, v117
  s_waitcnt vmcnt(7)
  v_mfma_f32_16x16x32_bf16 v[32:35], v[122:125], v[64:67], 0
  v_mfma_f32_16x16x32_bf16 v[36:39], v[120:123], v[64:67], 0
  s_waitcnt vmcnt(6)
  v_mfma_f32_16x16x32_bf16 v[32:35], v[126:129], v[68:71], v[32:35]
  v_mfma_f32_16x16x32_bf16 v[36:39], v[124:127], v[68:71], v[36:39]
  s_waitcnt vmcnt(5)
  v_mfma_f32_16x16x32_bf16 v[32:35], v[130:133], v[72:75], v[32:35]
  v_mfma_f32_16x16x32_bf16 v[36:39], v[128:131], v[72:75], v[36:39]
  s_waitcnt vmcnt(4)
  v_mfma_f32_16x16x32_bf16 v[32:35], v[134:137], v[76:79], v[32:35]
  v_mfma_f32_16x16x32_bf16 v[36:39], v[132:135], v[76:79], v[36:39]
  s_waitcnt vmcnt(3)
  v_mfma_f32_16x16x32_bf16 v[32:35], v[138:141], v[80:83], v[32:35]
  v_mfma_f32_16x16x32_bf16 v[36:39], v[136:139], v[80:83], v[36:39]
  s_waitcnt vmcnt(2)
  v_mfma_f32_16x16x32_bf16 v[32:35], v[142:145], v[84:87], v[32:35]
  v_mfma_f32_16x16x32_bf16 v[36:39], v[140:143], v[84:87], v[36:39]
  s_waitcnt vmcnt(1)
  v_mfma_f32_16x16x32_bf16 v[32:35], v[146:149], v[88:91], v[32:35]
  v_mfma_f32_16x16x32_bf16 v[36:39], v[144:147], v[88:91], v[36:39]
  s_waitcnt vmcnt(0)
  v_mfma_f32_16x16x32_bf16 v[32:35], v[150:153], v[92:95], v[32:35]
  v_mfma_f32_16x16x32_bf16 v[36:39], v[148:151], v[92:95], v[36:39]
  s_nop 7
  v_permlane16_swap_b32 v32, v36
  v_permlane16_swap_b32 v33, v37
  v_permlane16_swap_b32 v34, v38
  v_permlane16_swap_b32 v35, v39
  v_add_f32_dpp v160, v36, v32 row_ror:8 row_mask:0xf bank_mask:0xf
  v_add_f32_dpp v162, v37, v33 row_ror:8 row_mask:0xf bank_mask:0xf
  v_add_f32_dpp v164, v38, v34 row_ror:8 row_mask:0xf bank_mask:0xf
  v_add_f32_dpp v166, v39, v35 row_ror:8 row_mask:0xf bank_mask:0xf
  s_mov_b32 exec_lo, 0x00ff00ff
  s_mov_b32 exec_hi, 0x00ff00ff
  buffer_store_dwordx4 v[160:163], v13, s[12:15], s26 offen sc1
  buffer_store_dwordx4 v[164:167], v13, s[12:15], s26 offen offset:512 sc1
  s_nop 0
  s_branch L_hinit
.p2align 6
L_mlp1:
  v_and_b32 v13, 7, v0
  v_or_b32 v116, v4, v6
  v_or_b32 v117, v5, v7
  v_mov_b32 v120, 0
  v_mov_b32 v121, 0
  v_mov_b32 v124, 0
  v_mov_b32 v125, 0
  v_mov_b32 v128, 0
  v_mov_b32 v129, 0
  v_mov_b32 v132, 0
  v_mov_b32 v133, 0
  v_mov_b32 v136, 0
  v_mov_b32 v137, 0
  v_mov_b32 v140, 0
  v_mov_b32 v141, 0
  v_mov_b32 v144, 0
  v_mov_b32 v145, 0
  v_mov_b32 v148, 0
  v_mov_b32 v149, 0
  v_mov_b32 v152, 0
  v_mov_b32 v153, 0
  v_lshlrev_b32 v13, 4, v13
  v_lshl_or_b32 v13, v2, 7, v13
  s_lshl_b32 s26, s2, 10
  s_add_u32 s26, s26, 655360
  v_lshlrev_b32 v96, 16, v32
  v_and_b32 v97, 0xffff0000, v32
  v_lshlrev_b32 v98, 16, v33
  v_and_b32 v99, 0xffff0000, v33
  v_lshlrev_b32 v100, 16, v34
  v_and_b32 v101, 0xffff0000, v34
  v_lshlrev_b32 v102, 16, v35
  v_and_b32 v103, 0xffff0000, v35
  v_lshlrev_b32 v104, 16, v36
  v_and_b32 v105, 0xffff0000, v36
  v_lshlrev_b32 v106, 16, v37
  v_and_b32 v107, 0xffff0000, v37
  v_lshlrev_b32 v108, 16, v38
  v_and_b32 v109, 0xffff0000, v38
  v_lshlrev_b32 v110, 16, v39
  v_and_b32 v111, 0xffff0000, v39
  v_pk_add_f32 v[48:49], v[96:97], v[98:99]
  v_pk_add_f32 v[50:51], v[100:101], v[102:103]
  v_pk_add_f32 v[48:49], v[48:49], v[104:105]
  v_pk_add_f32 v[50:51], v[50:51], v[106:107]
  v_pk_add_f32 v[48:49], v[48:49], v[108:109]
  v_pk_add_f32 v[50:51], v[50:51], v[110:111]
  v_pk_add_f32 v[48:49], v[48:49], v[50:51]
  v_add_f32 v48, v48, v49
  s_nop 1
  v_add_f32_dpp v48, v48, v48 quad_perm:[1,0,3,2] row_mask:0xf bank_mask:0xf
  s_nop 1
  v_add_f32_dpp v48, v48, v48 quad_perm:[2,3,0,1] row_mask:0xf bank_mask:0xf
  s_nop 1
  v_add_f32_dpp v48, v48, v48 row_half_mirror row_mask:0xf bank_mask:0xf
  v_mov_b32 v49, v48
  s_nop 1
  v_permlane16_swap_b32 v48, v49
  v_add_f32 v48, v48, v49
  v_mov_b32 v49, v48
  s_nop 1
  v_permlane32_swap_b32 v48, v49
  v_add_f32 v48, v48, v49
  v_mul_f32 v48, 0x3b000000, v48
  v_pk_add_f32 v[96:97], v[96:97], v[48:49] op_sel_hi:[1,0] neg_lo:[0,1] neg_hi:[0,1]
  v_pk_add_f32 v[98:99], v[98:99], v[48:49] op_sel_hi:[1,0] neg_lo:[0,1] neg_hi:[0,1]
  v_pk_add_f32 v[100:101], v[100:101], v[48:49] op_sel_hi:[1,0] neg_lo:[0,1] neg_hi:[0,1]
  v_pk_add_f32 v[102:103], v[102:103], v[48:49] op_sel_hi:[1,0] neg_lo:[0,1] neg_hi:[0,1]
  v_pk_add_f32 v[104:105], v[104:105], v[48:49] op_sel_hi:[1,0] neg_lo:[0,1] neg_hi:[0,1]
  v_pk_add_f32 v[106:107], v[106:107], v[48:49] op_sel_hi:[1,0] neg_lo:[0,1] neg_hi:[0,1]
  v_pk_add_f32 v[108:109], v[108:109], v[48:49] op_sel_hi:[1,0] neg_lo:[0,1] neg_hi:[0,1]
  v_pk_add_f32 v[110:111], v[110:111], v[48:49] op_sel_hi:[1,0] neg_lo:[0,1] neg_hi:[0,1]
  v_pk_mul_f32 v[50:51], v[96:97], v[96:97]
  v_pk_mul_f32 v[52:53], v[98:99], v[98:99]
  v_pk_fma_f32 v[50:51], v[100:101], v[100:101], v[50:51]
  v_pk_fma_f32 v[52:53], v[102:103], v[102:103], v[52:53]
  v_pk_fma_f32 v[50:51], v[104:105], v[104:105], v[50:51]
  v_pk_fma_f32 v[52:53], v[106:107], v[106:107], v[52:53]
  v_pk_fma_f32 v[50:51], v[108:109], v[108:109], v[50:51]
  v_pk_fma_f32 v[52:53], v[110:111], v[110:111], v[52:53]
  v_pk_add_f32 v[50:51], v[50:51], v[52:53]
  v_add_f32 v50, v50, v51
  s_nop 1
  v_add_f32_dpp v50, v50, v50 quad_perm:[1,0,3,2] row_mask:0xf bank_mask:0xf
  s_nop 1
  v_add_f32_dpp v50, v50, v50 quad_perm:[2,3,0,1] row_mask:0xf bank_mask:0xf
  s_nop 1
  v_add_f32_dpp v50, v50, v50 row_half_mirror row_mask:0xf bank_mask:0xf
  v_mov_b32 v51, v50
  s_nop 1
  v_permlane16_swap_b32 v50, v51
  v_add_f32 v50, v50, v51
  v_mov_b32 v51, v50
  s_nop 1
  v_permlane32_swap_b32 v50, v51
  v_add_f32 v50, v50, v51
  v_mul_f32 v50, 0x3b000000, v50
  v_cvt_pk_bf16_f32 v49, v48, v50
  v_lshlrev_b32 v48, 16, v49
  v_and_b32 v50, 0xffff0000, v49
  v_add_f32 v50, 0x3727c5ac, v50
  v_cvt_pk_bf16_f32 v50, v50, v50
  v_and_b32 v50, 0xffff0000, v50
  v_sqrt_f32 v50, v50
  s_nop 0
  v_cvt_pk_bf16_f32 v50, v50, v50
  v_and_b32 v50, 0xffff0000, v50
  v_rcp_f32 v50, v50
  v_lshlrev_b32 v96, 16, v32
  v_and_b32 v97, 0xffff0000, v32
  v_lshlrev_b32 v98, 16, v33
  v_and_b32 v99, 0xffff0000, v33
  v_lshlrev_b32 v100, 16, v34
  v_and_b32 v101, 0xffff0000, v34
  v_lshlrev_b32 v102, 16, v35
  v_and_b32 v103, 0xffff0000, v35
  v_lshlrev_b32 v104, 16, v36
  v_and_b32 v105, 0xffff0000, v36
  v_lshlrev_b32 v106, 16, v37
  v_and_b32 v107, 0xffff0000, v37
  v_lshlrev_b32 v108, 16, v38
  v_and_b32 v109, 0xffff0000, v38
  v_lshlrev_b32 v110, 16, v39
  v_and_b32 v111, 0xffff0000, v39
  v_pk_add_f32 v[96:97], v[96:97], v[48:49] op_sel_hi:[1,0] neg_lo:[0,1] neg_hi:[0,1]
  v_pk_add_f32 v[98:99], v[98:99], v[48:49] op_sel_hi:[1,0] neg_lo:[0,1] neg_hi:[0,1]
  v_pk_add_f32 v[100:101], v[100:101], v[48:49] op_sel_hi:[1,0] neg_lo:[0,1] neg_hi:[0,1]
  v_pk_add_f32 v[102:103], v[102:103], v[48:49] op_sel_hi:[1,0] neg_lo:[0,1] neg_hi:[0,1]
  v_pk_add_f32 v[104:105], v[104:105], v[48:49] op_sel_hi:[1,0] neg_lo:[0,1] neg_hi:[0,1]
  v_pk_add_f32 v[106:107], v[106:107], v[48:49] op_sel_hi:[1,0] neg_lo:[0,1] neg_hi:[0,1]
  v_pk_add_f32 v[108:109], v[108:109], v[48:49] op_sel_hi:[1,0] neg_lo:[0,1] neg_hi:[0,1]
  v_pk_add_f32 v[110:111], v[110:111], v[48:49] op_sel_hi:[1,0] neg_lo:[0,1] neg_hi:[0,1]
  v_cvt_pk_bf16_f32 v32, v96, v97
  v_cvt_pk_bf16_f32 v33, v98, v99
  v_cvt_pk_bf16_f32 v34, v100, v101
  v_cvt_pk_bf16_f32 v35, v102, v103
  v_cvt_pk_bf16_f32 v36, v104, v105
  v_cvt_pk_bf16_f32 v37, v106, v107
  v_cvt_pk_bf16_f32 v38, v108, v109
  v_cvt_pk_bf16_f32 v39, v110, v111
  v_lshlrev_b32 v96, 16, v32
  v_and_b32 v97, 0xffff0000, v32
  v_lshlrev_b32 v98, 16, v33
  v_and_b32 v99, 0xffff0000, v33
  v_lshlrev_b32 v100, 16, v34
  v_and_b32 v101, 0xffff0000, v34
  v_lshlrev_b32 v102, 16, v35
  v_and_b32 v103, 0xffff0000, v35
  v_lshlrev_b32 v104, 16, v36
  v_and_b32 v105, 0xffff0000, v36
  v_lshlrev_b32 v106, 16, v37
  v_and_b32 v107, 0xffff0000, v37
  v_lshlrev_b32 v108, 16, v38
  v_and_b32 v109, 0xffff0000, v38
  v_lshlrev_b32 v110, 16, v39
  v_and_b32 v111, 0xffff0000, v39
  v_pk_mul_f32 v[96:97], v[96:97], v[50:51] op_sel_hi:[1,0]
  v_pk_mul_f32 v[98:99], v[98:99], v[50:51] op_sel_hi:[1,0]
  v_pk_mul_f32 v[100:101], v[100:101], v[50:51] op_sel_hi:[1,0]
  v_pk_mul_f32 v[102:103], v[102:103], v[50:51] op_sel_hi:[1,0]
  v_pk_mul_f32 v[104:105], v[104:105], v[50:51] op_sel_hi:[1,0]
  v_pk_mul_f32 v[106:107], v[106:107], v[50:51] op_sel_hi:[1,0]
  v_pk_mul_f32 v[108:109], v[108:109], v[50:51] op_sel_hi:[1,0]
  v_pk_mul_f32 v[110:111], v[110:111], v[50:51] op_sel_hi:[1,0]
  v_cvt_pk_bf16_f32 v32, v96, v97
  v_cvt_pk_bf16_f32 v33, v98, v99
  v_cvt_pk_bf16_f32 v34, v100, v101
  v_cvt_pk_bf16_f32 v35, v102, v103
  v_cvt_pk_bf16_f32 v36, v104, v105
  v_cvt_pk_bf16_f32 v37, v106, v107
  v_cvt_pk_bf16_f32 v38, v108, v109
  v_cvt_pk_bf16_f32 v39, v110, v111
  v_lshlrev_b32 v96, 16, v32
  v_and_b32 v97, 0xffff0000, v32
  v_lshlrev_b32 v98, 16, v33
  v_and_b32 v99, 0xffff0000, v33
  v_lshlrev_b32 v100, 16, v34
  v_and_b32 v101, 0xffff0000, v34
  v_lshlrev_b32 v102, 16, v35
  v_and_b32 v103, 0xffff0000, v35
  v_lshlrev_b32 v104, 16, v36
  v_and_b32 v105, 0xffff0000, v36
  v_lshlrev_b32 v106, 16, v37
  v_and_b32 v107, 0xffff0000, v37
  v_lshlrev_b32 v108, 16, v38
  v_and_b32 v109, 0xffff0000, v38
  v_lshlrev_b32 v110, 16, v39
  v_and_b32 v111, 0xffff0000, v39
  v_pk_add_f32 v[54:55], v[96:97], v[98:99]
  v_pk_add_f32 v[56:57], v[100:101], v[102:103]
  v_pk_add_f32 v[54:55], v[54:55], v[104:105]
  v_pk_add_f32 v[56:57], v[56:57], v[106:107]
  v_pk_add_f32 v[54:55], v[54:55], v[108:109]
  v_pk_add_f32 v[56:57], v[56:57], v[110:111]
  v_pk_add_f32 v[54:55], v[54:55], v[56:57]
  v_add_f32 v54, v54, v55
  s_nop 1
  v_add_f32_dpp v54, v54, v54 quad_perm:[1,0,3,2] row_mask:0xf bank_mask:0xf
  s_nop 1
  v_add_f32_dpp v54, v54, v54 quad_perm:[2,3,0,1] row_mask:0xf bank_mask:0xf
  s_nop 1
  v_add_f32_dpp v54, v54, v54 row_half_mirror row_mask:0xf bank_mask:0xf
  v_mov_b32 v55, v54
  s_nop 1
  v_permlane16_swap_b32 v54, v55
  v_add_f32 v54, v54, v55
  v_mov_b32 v55, v54
  s_nop 1
  v_permlane32_swap_b32 v54, v55
  v_add_f32 v54, v54, v55
  v_mul_f32 v54, 0x3b000000, v54
  v_pk_add_f32 v[96:97], v[96:97], v[54:55] op_sel_hi:[1,0] neg_lo:[0,1] neg_hi:[0,1]
  v_pk_add_f32 v[98:99], v[98:99], v[54:55] op_sel_hi:[1,0] neg_lo:[0,1] neg_hi:[0,1]
  v_pk_add_f32 v[100:101], v[100:101], v[54:55] op_sel_hi:[1,0] neg_lo:[0,1] neg_hi:[0,1]
  v_pk_add_f32 v[102:103], v[102:103], v[54:55] op_sel_hi:[1,0] neg_lo:[0,1] neg_hi:[0,1]
  v_pk_add_f32 v[104:105], v[104:105], v[54:55] op_sel_hi:[1,0] neg_lo:[0,1] neg_hi:[0,1]
  v_pk_add_f32 v[106:107], v[106:107], v[54:55] op_sel_hi:[1,0] neg_lo:[0,1] neg_hi:[0,1]
  v_pk_add_f32 v[108:109], v[108:109], v[54:55] op_sel_hi:[1,0] neg_lo:[0,1] neg_hi:[0,1]
  v_pk_add_f32 v[110:111], v[110:111], v[54:55] op_sel_hi:[1,0] neg_lo:[0,1] neg_hi:[0,1]
  v_pk_mul_f32 v[56:57], v[96:97], v[96:97]
  v_pk_mul_f32 v[58:59], v[98:99], v[98:99]
  v_pk_fma_f32 v[56:57], v[100:101], v[100:101], v[56:57]
  v_pk_fma_f32 v[58:59], v[102:103], v[102:103], v[58:59]
  v_pk_fma_f32 v[56:57], v[104:105], v[104:105], v[56:57]
  v_pk_fma_f32 v[58:59], v[106:107], v[106:107], v[58:59]
  v_pk_fma_f32 v[56:57], v[108:109], v[108:109], v[56:57]
  v_pk_fma_f32 v[58:59], v[110:111], v[110:111], v[58:59]
  v_pk_add_f32 v[56:57], v[56:57], v[58:59]
  v_add_f32 v56, v56, v57
  s_nop 1
  v_add_f32_dpp v56, v56, v56 quad_perm:[1,0,3,2] row_mask:0xf bank_mask:0xf
  s_nop 1
  v_add_f32_dpp v56, v56, v56 quad_perm:[2,3,0,1] row_mask:0xf bank_mask:0xf
  s_nop 1
  v_add_f32_dpp v56, v56, v56 row_half_mirror row_mask:0xf bank_mask:0xf
  v_mov_b32 v57, v56
  s_nop 1
  v_permlane16_swap_b32 v56, v57
  v_add_f32 v56, v56, v57
  v_mov_b32 v57, v56
  s_nop 1
  v_permlane32_swap_b32 v56, v57
  v_add_f32 v56, v56, v57
  v_mul_f32 v56, 0x3b000000, v56
  v_cvt_pk_bf16_f32 v55, v54, v56
  v_lshlrev_b32 v54, 16, v55
  v_and_b32 v56, 0xffff0000, v55
  v_add_f32 v56, 0x3727c5ac, v56
  v_cvt_pk_bf16_f32 v56, v56, v56
  v_and_b32 v56, 0xffff0000, v56
  v_sqrt_f32 v56, v56
  s_nop 0
  v_cvt_pk_bf16_f32 v56, v56, v56
  v_and_b32 v56, 0xffff0000, v56
  v_rcp_f32 v56, v56
  v_lshlrev_b32 v96, 16, v40
  v_and_b32 v97, 0xffff0000, v40
  v_lshlrev_b32 v98, 16, v41
  v_and_b32 v99, 0xffff0000, v41
  v_lshlrev_b32 v100, 16, v42
  v_and_b32 v101, 0xffff0000, v42
  v_lshlrev_b32 v102, 16, v43
  v_and_b32 v103, 0xffff0000, v43
  v_pk_add_f32 v[96:97], v[96:97], v[48:49] op_sel_hi:[1,0] neg_lo:[0,1] neg_hi:[0,1]
  v_pk_add_f32 v[98:99], v[98:99], v[48:49] op_sel_hi:[1,0] neg_lo:[0,1] neg_hi:[0,1]
  v_pk_add_f32 v[100:101], v[100:101], v[48:49] op_sel_hi:[1,0] neg_lo:[0,1] neg_hi:[0,1]
  v_pk_add_f32 v[102:103], v[102:103], v[48:49] op_sel_hi:[1,0] neg_lo:[0,1] neg_hi:[0,1]
  v_cvt_pk_bf16_f32 v40, v96, v97
  v_cvt_pk_bf16_f32 v41, v98, v99
  v_cvt_pk_bf16_f32 v42, v100, v101
  v_cvt_pk_bf16_f32 v43, v102, v103
  v_lshlrev_b32 v96, 16, v40
  v_and_b32 v97, 0xffff0000, v40
  v_lshlrev_b32 v98, 16, v41
  v_and_b32 v99, 0xffff0000, v41
  v_lshlrev_b32 v100, 16, v42
  v_and_b32 v101, 0xffff0000, v42
  v_lshlrev_b32 v102, 16, v43
  v_and_b32 v103, 0xffff0000, v43
  v_pk_mul_f32 v[96:97], v[96:97], v[50:51] op_sel_hi:[1,0]
  v_pk_mul_f32 v[98:99], v[98:99], v[50:51] op_sel_hi:[1,0]
  v_pk_mul_f32 v[100:101], v[100:101], v[50:51] op_sel_hi:[1,0]
  v_pk_mul_f32 v[102:103], v[102:103], v[50:51] op_sel_hi:[1,0]
  v_cvt_pk_bf16_f32 v40, v96, v97
  v_cvt_pk_bf16_f32 v41, v98, v99
  v_cvt_pk_bf16_f32 v42, v100, v101
  v_cvt_pk_bf16_f32 v43, v102, v103
  v_lshlrev_b32 v96, 16, v40
  v_and_b32 v97, 0xffff0000, v40
  v_lshlrev_b32 v98, 16, v41
  v_and_b32 v99, 0xffff0000, v41
  v_lshlrev_b32 v100, 16, v42
  v_and_b32 v101, 0xffff0000, v42
  v_lshlrev_b32 v102, 16, v43
  v_and_b32 v103, 0xffff0000, v43
  v_pk_add_f32 v[96:97], v[96:97], v[54:55] op_sel_hi:[1,0] neg_lo:[0,1] neg_hi:[0,1]
  v_pk_add_f32 v[98:99], v[98:99], v[54:55] op_sel_hi:[1,0] neg_lo:[0,1] neg_hi:[0,1]
  v_pk_add_f32 v[100:101], v[100:101], v[54:55] op_sel_hi:[1,0] neg_lo:[0,1] neg_hi:[0,1]
  v_pk_add_f32 v[102:103], v[102:103], v[54:55] op_sel_hi:[1,0] neg_lo:[0,1] neg_hi:[0,1]
  v_cvt_pk_bf16_f32 v40, v96, v97
  v_cvt_pk_bf16_f32 v41, v98, v99
  v_cvt_pk_bf16_f32 v42, v100, v101
  v_cvt_pk_bf16_f32 v43, v102, v103
  v_lshlrev_b32 v96, 16, v40
  v_and_b32 v97, 0xffff0000, v40
  v_lshlrev_b32 v98, 16, v41
  v_and_b32 v99, 0xffff0000, v41
  v_lshlrev_b32 v100, 16, v42
  v_and_b32 v101, 0xffff0000, v42
  v_lshlrev_b32 v102, 16, v43
  v_and_b32 v103, 0xffff0000, v43
  v_pk_mul_f32 v[96:97], v[96:97], v[56:57] op_sel_hi:[1,0]
  v_pk_mul_f32 v[98:99], v[98:99], v[56:57] op_sel_hi:[1,0]
  v_pk_mul_f32 v[100:101], v[100:101], v[56:57] op_sel_hi:[1,0]
  v_pk_mul_f32 v[102:103], v[102:103], v[56:57] op_sel_hi:[1,0]
  v_cvt_pk_bf16_f32 v104, v96, v96
  v_cvt_pk_bf16_f32 v105, v97, v97
  v_cvt_pk_bf16_f32 v106, v98, v98
  v_cvt_pk_bf16_f32 v107, v99, v99
  v_cvt_pk_bf16_f32 v108, v100, v100
  v_cvt_pk_bf16_f32 v109, v101, v101
  v_cvt_pk_bf16_f32 v110, v102, v102
  v_cvt_pk_bf16_f32 v111, v103, v103
  v_and_b32 v122, v104, v116
  v_and_b32 v123, v104, v117
  v_and_b32 v126, v105, v116
  v_and_b32 v127, v105, v117
  v_and_b32 v130, v106, v116
  v_and_b32 v131, v106, v117
  v_and_b32 v134, v107, v116
  v_and_b32 v135, v107, v117
  v_and_b32 v138, v108, v116
  v_and_b32 v139, v108, v117
  v_and_b32 v142, v109, v116
  v_and_b32 v143, v109, v117
  v_and_b32 v146, v110, v116
  v_and_b32 v147, v110, v117
  v_and_b32 v150, v111, v116
  v_and_b32 v151, v111, v117
  v_mfma_f32_16x16x32_bf16 v[32:35], v[122:125], v[64:67], 0
  v_mfma_f32_16x16x32_bf16 v[36:39], v[120:123], v[64:67], 0
  v_mfma_f32_16x16x32_bf16 v[32:35], v[126:129], v[68:71], v[32:35]
  v_mfma_f32_16x16x32_bf16 v[36:39], v[124:127], v[68:71], v[36:39]
  v_mfma_f32_16x16x32_bf16 v[32:35], v[130:133], v[72:75], v[32:35]
  v_mfma_f32_16x16x32_bf16 v[36:39], v[128:131], v[72:75], v[36:39]
  v_mfma_f32_16x16x32_bf16 v[32:35], v[134:137], v[76:79], v[32:35]
  v_mfma_f32_16x16x32_bf16 v[36:39], v[132:135], v[76:79], v[36:39]
  v_mfma_f32_16x16x32_bf16 v[32:35], v[138:141], v[80:83], v[32:35]
  v_mfma_f32_16x16x32_bf16 v[36:39], v[136:139], v[80:83], v[36:39]
  v_mfma_f32_16x16x32_bf16 v[32:35], v[142:145], v[84:87], v[32:35]
  v_mfma_f32_16x16x32_bf16 v[36:39], v[140:143], v[84:87], v[36:39]
  v_mfma_f32_16x16x32_bf16 v[32:35], v[146:149], v[88:91], v[32:35]
  v_mfma_f32_16x16x32_bf16 v[36:39], v[144:147], v[88:91], v[36:39]
  v_mfma_f32_16x16x32_bf16 v[32:35], v[150:153], v[92:95], v[32:35]
  v_mfma_f32_16x16x32_bf16 v[36:39], v[148:151], v[92:95], v[36:39]
  v_mov_b32 v65, s21
  v_mov_b32 v67, s21
  v_mov_b32 v69, s21
  v_mov_b32 v71, s21
  s_nop 3
  v_permlane16_swap_b32 v32, v36
  v_permlane16_swap_b32 v33, v37
  v_permlane16_swap_b32 v34, v38
  v_permlane16_swap_b32 v35, v39
  v_add_f32_dpp v64, v36, v32 row_ror:8 row_mask:0xf bank_mask:0xf
  v_add_f32_dpp v66, v37, v33 row_ror:8 row_mask:0xf bank_mask:0xf
  v_add_f32_dpp v68, v38, v34 row_ror:8 row_mask:0xf bank_mask:0xf
  v_add_f32_dpp v70, v39, v35 row_ror:8 row_mask:0xf bank_mask:0xf
  s_mov_b32 exec_lo, 0x00ff00ff
  s_mov_b32 exec_hi, 0x00ff00ff
  buffer_store_dwordx4 v[64:67], v13, s[12:15], s26 offen sc1
  buffer_store_dwordx4 v[68:71], v13, s[12:15], s26 offen offset:512 sc1
  s_mov_b64 exec, -1
  s_branch L_tail
.p2align 6
L_mlp2:
  s_lshr_b32 s26, s24, 2
  s_lshl_b32 s27, s25, 1
  s_add_u32 s27, s27, s26
  s_and_b32 s24, s24, 3
  v_lshlrev_b32 v13, 1, v47
  v_and_b32 v14, 1, v2
  v_lshl_or_b32 v13, v14, 8, v13
  s_lshl_b32 s26, s26, 7
  v_lshlrev_b32 v14, 5, v2
  v_lshl_or_b32 v14, v1, 8, v14
  v_add_u32 v14, s26, v14
  s_lshl_b32 s24, s24, 6
  s_add_u32 s29, s24, s27
  s_mul_i32 s29, s29, 2048
  s_add_u32 s29, s29, 4194304
  s_lshl_b32 s26, s25, 13
  s_add_u32 s26, s26, 655360
  s_add_u32 s27, s26, 4096
  v_lshlrev_b32 v15, 10, v0
  s_movk_i32 s56, 0xff
  s_mov_b32 s57, 0
  s_mov_b64 exec, -1
  s_mov_b64 s[32:33], -1
  s_mov_b64 s[34:35], -1
  s_mov_b64 s[36:37], -1
  s_mov_b64 s[38:39], -1
  s_mov_b64 s[40:41], -1
  s_mov_b64 s[42:43], -1
  s_mov_b64 s[44:45], -1
  s_mov_b64 s[46:47], -1
L_poll4:
  s_mov_b64 exec, s[32:33]
  buffer_load_dwordx4 v[128:131], v12, s[12:15], s26 offen offset:0 sc1
  s_mov_b64 exec, s[34:35]
  buffer_load_dwordx4 v[132:135], v12, s[12:15], s26 offen offset:1024 sc1
  s_mov_b64 exec, s[36:37]
  buffer_load_dwordx4 v[136:139], v12, s[12:15], s26 offen offset:2048 sc1
  s_mov_b64 exec, s[38:39]
  buffer_load_dwordx4 v[140:143], v12, s[12:15], s26 offen offset:3072 sc1
  s_mov_b64 exec, s[40:41]
  buffer_load_dwordx4 v[144:147], v12, s[12:15], s27 offen offset:0 sc1
  s_mov_b64 exec, s[42:43]
  buffer_load_dwordx4 v[148:151], v12, s[12:15], s27 offen offset:1024 sc1
  s_mov_b64 exec, s[44:45]
  buffer_load_dwordx4 v[152:155], v12, s[12:15], s27 offen offset:2048 sc1
  s_mov_b64 exec, s[46:47]
  buffer_load_dwordx4 v[156:159], v12, s[12:15], s27 offen offset:3072 sc1
  s_mov_b32 s58, 0
  s_waitcnt vmcnt(0)
  s_mov_b64 exec, s[32:33]
  v_cmpx_eq_u32 vcc, s21, v129
  v_cmpx_eq_u32 vcc, s21, v131
  s_andn2_b64 s[32:33], s[32:33], exec
  s_addc_u32 s58, s58, 0
  s_mov_b64 exec, s[34:35]
  v_cmpx_eq_u32 vcc, s21, v133
  v_cmpx_eq_u32 vcc, s21, v135
  s_andn2_b64 s[34:35], s[34:35], exec
  s_addc_u32 s58, s58, 0
  s_mov_b64 exec, s[36:37]
  v_cmpx_eq_u32 vcc, s21, v137
  v_cmpx_eq_u32 vcc, s21, v139
  s_andn2_b64 s[36:37], s[36:37], exec
  s_addc_u32 s58, s58, 0
  s_mov_b64 exec, s[38:39]
  v_cmpx_eq_u32 vcc, s21, v141
  v_cmpx_eq_u32 vcc, s21, v143
  s_andn2_b64 s[38:39], s[38:39], exec
  s_addc_u32 s58, s58, 0
  s_mov_b64 exec, s[40:41]
  v_cmpx_eq_u32 vcc, s21, v145
  v_cmpx_eq_u32 vcc, s21, v147
  s_andn2_b64 s[40:41], s[40:41], exec
  s_addc_u32 s58, s58, 0
  s_mov_b64 exec, s[42:43]
  v_cmpx_eq_u32 vcc, s21, v149
  v_cmpx_eq_u32 vcc, s21, v151
  s_andn2_b64 s[42:43], s[42:43], exec
  s_addc_u32 s58, s58, 0
  s_mov_b64 exec, s[44:45]
  v_cmpx_eq_u32 vcc, s21, v153
  v_cmpx_eq_u32 vcc, s21, v155
  s_andn2_b64 s[44:45], s[44:45], exec
  s_addc_u32 s58, s58, 0
  s_mov_b64 exec, s[46:47]
  v_cmpx_eq_u32 vcc, s21, v157
  v_cmpx_eq_u32 vcc, s21, v159
  s_andn2_b64 s[46:47], s[46:47], exec
  s_addc_u32 s58, s58, 0
  s_mov_b64 exec, -1
  s_cmp_eq_u32 s58, 0
  s_cbranch_scc1 L_pok4
  s_sleep 16
  s_sub_u32 s22, s22, 1
  s_cbranch_scc0 L_poll4
  s_mov_b32 s22, 0
L_pok4:
  v_add_f32 v128, v128, v132
  v_add_f32 v130, v130, v134
  v_add_f32 v136, v136, v140
  v_add_f32 v138, v138, v142
  v_add_f32 v144, v144, v148
  v_add_f32 v146, v146, v150
  v_add_f32 v152, v152, v156
  v_add_f32 v154, v154, v158
  v_add_f32 v128, v128, v136
  v_add_f32 v130, v130, v138
  v_add_f32 v144, v144, v152
  v_add_f32 v146, v146, v154
  v_add_f32 v128, v128, v144
  v_add_f32 v130, v130, v146
  v_cvt_pk_bf16_f32 v32, v128, v130
  v_lshlrev_b32 v36, 16, v32
  v_and_b32 v37, 0xffff0000, v32
  v_lshlrev_b32 v40, 16, v62
  v_and_b32 v41, 0xffff0000, v62
  v_add_f32 v36, v36, v40
  v_add_f32 v37, v37, v41
  v_cvt_pk_bf16_f32 v32, v36, v37
  v_lshlrev_b32 v36, 16, v32
  v_and_b32 v37, 0xffff0000, v32
  s_mov_b32 s26, 0xbdd2d3e8
  v_mov_b32 v44, 0xc0135761
  v_mul_f32 v40, v36, v36
  v_mul_f32 v41, v37, v37
  v_fma_f32 v40, v40, s26, v44
  v_fma_f32 v41, v41, s26, v44
  v_mul_f32 v40, v40, v36
  v_mul_f32 v41, v41, v37
  v_exp_f32 v40, v40
  v_exp_f32 v41, v41
  v_add_f32 v40, 1.0, v40
  v_add_f32 v41, 1.0, v41
  v_rcp_f32 v40, v40
  v_rcp_f32 v41, v41
  v_mul_f32 v40, v40, v36
  v_mul_f32 v41, v41, v37
  v_cvt_pk_bf16_f32 v32, v40, v40
  v_cvt_pk_bf16_f32 v33, v41, v41
  ds_write_b64 v13, v[32:33] offset:12800
  s_waitcnt lgkmcnt(0)
  ds_read_b128 v[96:99], v14 offset:12800
  ds_read_b128 v[100:103], v14 offset:12816
  v_mov_b32 v37, s21
  v_mov_b32 v39, s21
  v_mov_b32 v41, s21
  v_mov_b32 v43, s21
  s_waitcnt lgkmcnt(0)
  v_and_b32 v160, v96, v4
  v_and_b32 v161, v96, v5
  v_and_b32 v162, v96, v6
  v_and_b32 v163, v96, v7
  v_and_b32 v164, v97, v4
  v_and_b32 v165, v97, v5
  v_and_b32 v166, v97, v6
  v_and_b32 v167, v97, v7
  v_and_b32 v168, v98, v4
  v_and_b32 v169, v98, v5
  v_and_b32 v170, v98, v6
  v_and_b32 v171, v98, v7
  v_and_b32 v172, v99, v4
  v_and_b32 v173, v99, v5
  v_and_b32 v174, v99, v6
  v_and_b32 v175, v99, v7
  v_and_b32 v176, v100, v4
  v_and_b32 v177, v100, v5
  v_and_b32 v178, v100, v6
  v_and_b32 v179, v100, v7
  v_and_b32 v180, v101, v4
  v_and_b32 v181, v101, v5
  v_and_b32 v182, v101, v6
  v_and_b32 v183, v101, v7
  v_and_b32 v184, v102, v4
  v_and_b32 v185, v102, v5
  v_and_b32 v186, v102, v6
  v_and_b32 v187, v102, v7
  v_and_b32 v188, v103, v4
  v_and_b32 v189, v103, v5
  v_and_b32 v190, v103, v6
  v_and_b32 v191, v103, v7
  v_mfma_f32_16x16x32_bf16 v[32:35], v[160:163], v[64:67], 0
  v_mfma_f32_16x16x32_bf16 v[32:35], v[164:167], v[68:71], v[32:35]
  v_mfma_f32_16x16x32_bf16 v[32:35], v[168:171], v[72:75], v[32:35]
  v_mfma_f32_16x16x32_bf16 v[32:35], v[172:175], v[76:79], v[32:35]
  v_mfma_f32_16x16x32_bf16 v[32:35], v[176:179], v[80:83], v[32:35]
  v_mfma_f32_16x16x32_bf16 v[32:35], v[180:183], v[84:87], v[32:35]
  v_mfma_f32_16x16x32_bf16 v[32:35], v[184:187], v[88:91], v[32:35]
  v_mfma_f32_16x16x32_bf16 v[32:35], v[188:191], v[92:95], v[32:35]
  s_nop 7
  v_mov_b32 v36, v32
  v_mov_b32 v38, v33
  v_mov_b32 v40, v34
  v_mov_b32 v42, v35
  buffer_store_dwordx4 v[36:39], v12, s[12:15], s29 offen sc1
  buffer_store_dwordx4 v[40:43], v12, s[12:15], s29 offen offset:1024 sc1
  s_nop 0
  s_branch L_tail
.section .rodata,"a"
.p2align 6
.amdhsa_kernel recurrent_scan__gqa_block_cached__mixer_channel_mlp__decode_kernel
  .amdhsa_next_free_vgpr 256
  .amdhsa_next_free_sgpr 102
  .amdhsa_accum_offset 256
  .amdhsa_group_segment_fixed_size 0
  .amdhsa_kernarg_size 104
  .amdhsa_user_sgpr_count 2
  .amdhsa_user_sgpr_kernarg_segment_ptr 1
  .amdhsa_system_sgpr_workgroup_id_x 1
.end_amdhsa_kernel
```
